```python
import torch

def _softmax(x, axis=-1):
    return torch.softmax(x, dim=axis)

def _gelu(x):
    return torch.nn.functional.gelu(x, approximate='tanh')

def _silu(x):
    return torch.nn.functional.silu(x)

def _sigmoid(x):
    return torch.sigmoid(x)

def _layernorm(x, axis=-1, eps=1e-05):
    m = x.mean(dim=axis, keepdim=True)
    v = x.var(dim=axis, keepdim=True, unbiased=False)
    return (x - m) / torch.sqrt(v + eps)

def _scatter_add(tgt, idx, src, axis=0):
    return tgt.clone().index_add_(axis, idx, src)

def _segment_sum(src, seg, n):
    out = torch.zeros((n,) + src.shape[1:], dtype=src.dtype)
    return out.index_add_(0, seg, src)

def _pad(x, pw):
    flat = tuple((v for pair in reversed(pw) for v in pair))
    return torch.nn.functional.pad(x, flat)
kernel_name = 'adaLN_cond__sliding_block_cached__geglu_ffn__decode'

def setup_inputs():

    _w = lambda a: (lambda t: t.to(torch.bfloat16) if t.is_floating_point() else t)(torch.as_tensor(a))

    def _A_setup():
        B, Sq, D = (2, 1, 512)
        Hq, Hkv, Sk, Dh = (32, 8, 32768, 128)
        assert Hq % Hkv == 0, (Hq, Hkv)
        return {'x': _w((lambda *s: torch.randn(*s, dtype=torch.bfloat16) * 0.05)(B, Sq, D)), 'k_cache': _w((lambda *s: torch.randn(*s, dtype=torch.bfloat16) * 3.2)(B, Hkv, Sk, Dh)), 'v_cache': _w((lambda *s: torch.randn(*s, dtype=torch.bfloat16) * 0.4)(B, Hkv, Sk, Dh)), 'wq': _w((lambda *s: torch.randn(*s, dtype=torch.bfloat16) * 3.2)(D, Hq * Dh) * D ** (-0.5)), 'wo': _w((lambda *s: torch.randn(*s, dtype=torch.bfloat16) * 0.4)(Hq * Dh, D) * (Hq * Dh) ** (-0.5))}
    _A_in = _A_setup()

    def _B_setup():
        B, S, D, F = (2, 1, 512, 1792)
        return {'x': _w((lambda *s: torch.randn(*s, dtype=torch.bfloat16) * 0.05)(B, S, D)), 'w_gate': _w((lambda *s: torch.randn(*s, dtype=torch.bfloat16) * 0.05)(D, F)), 'w_up': _w((lambda *s: torch.randn(*s, dtype=torch.bfloat16) * 0.05)(D, F)), 'w_down': _w((lambda *s: torch.randn(*s, dtype=torch.bfloat16) * 0.05)(F, D))}
    _B_in = _B_setup()
    return {'A_x': _A_in['x'], 'A_k_cache': _A_in['k_cache'], 'A_v_cache': _A_in['v_cache'], 'A_wq': _A_in['wq'], 'A_wo': _A_in['wo'], 'B_x': _B_in['x'], 'B_w_gate': _B_in['w_gate'], 'B_w_up': _B_in['w_up'], 'B_w_down': _B_in['w_down'], 'c': _w((lambda *s: torch.randn(*s, dtype=torch.bfloat16) * 0.2)(2, 512) * 8.0), 'w_mod': _w((lambda *s: torch.randn(*s, dtype=torch.bfloat16) * 0.2)(512, 6 * 512) * 512 ** (-0.5) * 8.0)}

def reference(A_x, A_k_cache, A_v_cache, A_wq, A_wo, B_x, B_w_gate, B_w_up, B_w_down, c, w_mod):

    def _A_ref(x, k_cache, v_cache, wq, wo):
        B, Sq, D = x.shape
        Hq, Dh = (32, 128)
        Hkv, Sk = (k_cache.shape[1], k_cache.shape[2])
        W = min(4096, max(256, Sk // 4))
        rep = Hq // Hkv
        q = (lambda x, *d: x.permute(*d))((x @ wq).reshape(B, Sq, Hq, Dh), 0, 2, 1, 3)
        k = (lambda x, n, axis: torch.repeat_interleave(x, n, dim=axis))(k_cache[:, :, Sk - W:, :], rep, axis=1)
        v = (lambda x, n, axis: torch.repeat_interleave(x, n, dim=axis))(v_cache[:, :, Sk - W:, :], rep, axis=1)
        scores = torch.einsum('bhqd,bhkd->bhqk', q, k) * Dh ** (-0.5)
        p = _softmax(scores, axis=-1)
        o = torch.einsum('bhqk,bhkd->bhqd', p, v)
        return (lambda x, *d: x.permute(*d))(o, 0, 2, 1, 3).reshape(B, Sq, Hq * Dh) @ wo

    def _B_ref(x, w_gate, w_up, w_down):
        return _gelu(x @ w_gate) * (x @ w_up) @ w_down
    x = A_x
    mod = (_silu(c) @ w_mod).reshape(c.shape[0], 6, 1, -1)
    sa, ca, ga, sb, cb, gb = (mod[:, 0].clone(), mod[:, 1].clone(), mod[:, 2].clone(), mod[:, 3].clone(), mod[:, 4].clone(), mod[:, 5].clone())
    h = _layernorm(x, axis=-1) * (1 + ca) + sa
    x = x + ga * _A_ref(h, A_k_cache, A_v_cache, A_wq, A_wo)
    h = _layernorm(x, axis=-1) * (1 + cb) + sb
    x = x + gb * _B_ref(h, B_w_gate, B_w_up, B_w_down)
    return x
```

```asm
; @launch grid=(256,1,1) block=(640,1,1) lds=152576
.amdgcn_target "amdgcn-amd-amdhsa--gfx950"
.text
.globl adaLN_cond__sliding_block_cached__geglu_ffn__decode_kernel
.p2align 8
.type adaLN_cond__sliding_block_cached__geglu_ffn__decode_kernel,@function
adaLN_cond__sliding_block_cached__geglu_ffn__decode_kernel:
    s_cmp_ge_u32 s2, 256
    s_cbranch_scc1 L_exit

    s_load_dwordx16 s[16:31], s[0:1], 0
    s_load_dwordx8 s[32:39], s[0:1], 64
    s_load_dwordx2 s[40:41], s[0:1], 104
    v_lshrrev_b32 v2, 6, v0
    v_and_b32 v0, 63, v0
    s_and_b32 s4, s2, 7
    v_readfirstlane_b32 s3, v2
    v_mov_b32 v4, 131072
    v_lshl_add_u32 v4, v0, 2, v4
    v_mov_b32 v5, 0xff800000
    v_cmp_gt_u32 vcc, 16, v0
    s_nop 1
    v_cndmask_b32 v5, v5, 0, vcc
    s_mov_b64 exec, 0xfffff
    ds_write_b32 v4, v5
    s_mov_b64 exec, -1
    s_lshr_b32 s5, s2, 3
    v_and_b32 v1, 15, v0
    v_lshrrev_b32 v2, 4, v0
    s_and_b32 s7, s5, 1
    s_lshr_b32 s69, s5, 1
    s_and_b32 s62, s5, 1
    s_mov_b32 s68, 0xffff0000
    s_mov_b32 s43, 0
    s_sub_u32 s58, s5, 8
    s_cmp_lt_u32 s58, 16
    s_cselect_b32 s99, 1, 0
    s_cmp_lt_u32 s4, 4
    s_cselect_b32 s58, 28, 24
    s_cmp_ge_u32 s5, s58
    s_cselect_b32 s99, 2, s99
    s_getpc_b64 s[56:57]
L_pc:
    s_sub_u32 s56, s56, L_pc-adaLN_cond__sliding_block_cached__geglu_ffn__decode_kernel
    s_subb_u32 s57, s57, 0
    s_mul_i32 s58, s3, 18
    v_add_u32 v6, s58, v0
    v_lshlrev_b32 v6, 7, v6
    v_min_u32 v6, L_code_end-adaLN_cond__sliding_block_cached__geglu_ffn__decode_kernel-4, v6
    s_mov_b64 exec, 0x3ffff
    global_load_dword v143, v6, s[56:57]
    s_mov_b64 exec, -1

    s_cmp_eq_u32 s3, 8
    s_cbranch_scc0 L_notloader

L_loader:
    s_lshl_b32 s57, s7, 3
    s_add_u32 s57, s57, s4
    s_lshl_b32 s57, s57, 15
    s_add_u32 s57, s57, 28672
    s_lshl_b32 s58, s69, 8
    s_add_u32 s57, s57, s58
    s_lshl_b32 s64, s57, 8
    v_lshrrev_b32 v16, 3, v0
    v_lshrrev_b32 v17, 1, v16
    v_and_b32 v17, 1, v17
    v_lshlrev_b32 v17, 1, v17
    v_and_b32 v18, 7, v0
    v_xor_b32 v17, v17, v18
    v_lshlrev_b32 v17, 4, v17

    s_cmp_eq_u32 s99, 0
    s_cbranch_scc1 L_ld_Mset
    v_mul_u32_u24 v19, 8192, v16
    s_sub_u32 s42, s5, 8
    s_lshr_b32 s42, s42, 1
    s_lshl_b32 s42, s42, 7
    s_lshl_b32 s58, s4, 10
    s_add_u32 s42, s42, s58
    s_mul_i32 s58, s62, 2097152
    s_add_u32 s42, s42, s58
    s_mov_b32 s67, 65536
    s_branch L_ld_set2
L_ld_Mset:
    v_mul_u32_u24 v19, 6144, v16

    s_lshl_b32 s57, s4, 3
    s_add_u32 s57, s57, s5
    s_lshl_b32 s58, s4, 2
    s_add_u32 s58, s58, s5
    s_add_u32 s58, s58, 40
    s_cmp_lt_u32 s5, 8
    s_cselect_b32 s57, s57, s58
    s_lshr_b32 s42, s57, 1

    s_lshl_b32 s42, s42, 7
    s_mul_i32 s58, s62, 1572864
    s_add_u32 s42, s42, s58
    s_mov_b32 s67, 49152
L_ld_set2:
    v_add_u32 v19, v19, v17
    v_xor_b32 v20, 64, v19

    s_waitcnt lgkmcnt(0)

    s_cmp_eq_u32 s99, 2
    s_cbranch_scc1 L_ld_K0
    s_cmp_eq_u32 s99, 0
    s_cselect_b32 s57, s36, s22
    s_cselect_b32 s58, s37, s23
    s_cselect_b32 s65, 3, 4
    s_lshl_b32 s65, s65, 20
    s_mov_b32 s48, s57
    s_and_b32 s49, s58, 0xffff
    s_mov_b32 s50, s65
    s_mov_b32 s51, 0x20000
    s_mov_b32 s66, 98304

    s_add_u32 s59, s66, 6144
L_dw0:
    s_mov_b32 m0, s66
    s_add_u32 s66, s66, 1024
    buffer_load_dwordx4 v19, s[48:51], s42 offen nt lds
    s_add_u32 s42, s42, s67
    s_mov_b32 m0, s66
    s_add_u32 s66, s66, 1024
    buffer_load_dwordx4 v20, s[48:51], s42 offen nt lds
    s_add_u32 s42, s42, s67
    s_cmp_lt_u32 s66, s59
    s_cbranch_scc1 L_dw0

    s_cmp_lt_u32 s5, 8
    s_cselect_b32 s57, s4, 7
    s_cmp_lt_u32 s57, 4
    s_cbranch_scc0 L_ld_W2

    s_add_u32 s59, s66, 26624
L_dw1:
    s_mov_b32 m0, s66
    s_add_u32 s66, s66, 1024
    buffer_load_dwordx4 v19, s[48:51], s42 offen nt lds
    s_add_u32 s42, s42, s67
    s_mov_b32 m0, s66
    s_add_u32 s66, s66, 1024
    buffer_load_dwordx4 v20, s[48:51], s42 offen nt lds
    s_add_u32 s42, s42, s67
    s_cmp_lt_u32 s66, s59
    s_cbranch_scc1 L_dw1

    s_barrier
    s_mov_b32 s12, s18
    s_and_b32 s13, s19, 0xffff
    s_mov_b32 s14, 134217728
    s_mov_b32 s15, 0x20000
    s_mov_b32 s44, s20
    s_and_b32 s45, s21, 0xffff
    s_mov_b32 s46, 134217728
    s_mov_b32 s47, 0x20000
    v_lshlrev_b32 v4, 8, v2
    v_add_u32 v5, 0, v2
    v_xor_b32 v5, v5, v1
    v_lshl_add_u32 v10, v5, 4, v4
    v_add_u32 v5, 4, v2
    v_xor_b32 v5, v5, v1
    v_lshl_add_u32 v11, v5, 4, v4
    v_add_u32 v5, 8, v2
    v_xor_b32 v5, v5, v1
    v_lshl_add_u32 v12, v5, 4, v4
    v_add_u32 v5, 12, v2
    v_xor_b32 v5, v5, v1
    v_lshl_add_u32 v13, v5, 4, v4
    v_add_u32 v5, 0, v2
    v_lshlrev_b32 v5, 1, v5
    v_xor_b32 v5, v5, v1
    v_lshl_add_u32 v14, v5, 4, v4
    v_add_u32 v5, 4, v2
    v_lshlrev_b32 v5, 1, v5
    v_xor_b32 v5, v5, v1
    v_lshl_add_u32 v15, v5, 4, v4
    s_waitcnt vmcnt(0)
    v_mov_b32 v4, 131092
    v_mov_b32 v5, 1
    s_mov_b64 exec, 1
    ds_write_b32 v4, v5
    s_mov_b64 exec, -1
    s_mul_i32 s98, s5, 5
    s_mul_i32 s57, s4, 3
    s_add_u32 s98, s98, s57
    s_and_b32 s98, s98, 15
    s_lshl_b32 s98, s98, 12
    s_mov_b32 s66, 8
L_km:
    s_mov_b32 m0, s98
    s_add_u32 s65, s64, s98
    buffer_load_dwordx4 v10, s[12:15], s65 offen nt lds
    s_add_u32 s98, s98, 1024
    s_waitcnt vmcnt(15)
    s_mov_b32 m0, s98
    s_add_u32 s65, s64, s98
    buffer_load_dwordx4 v11, s[12:15], s65 offen nt lds
    s_add_u32 s98, s98, 1024
    s_waitcnt vmcnt(15)
    s_mov_b32 m0, s98
    s_add_u32 s65, s64, s98
    buffer_load_dwordx4 v12, s[12:15], s65 offen nt lds
    s_add_u32 s98, s98, 1024
    s_waitcnt vmcnt(15)
    s_mov_b32 m0, s98
    s_add_u32 s65, s64, s98
    buffer_load_dwordx4 v13, s[12:15], s65 offen nt lds
    s_add_u32 s98, s98, 1024
    s_waitcnt vmcnt(15)
    s_and_b32 s98, s98, 0xffff
    s_sub_u32 s66, s66, 1
    s_cmp_lg_u32 s66, 0
    s_cbranch_scc1 L_km
    s_mov_b32 s66, 8
L_km2:
    s_mov_b32 m0, s98
    s_add_u32 s65, s64, s98
    buffer_load_dwordx4 v10, s[12:15], s65 offen nt lds
    s_add_u32 s98, s98, 1024
    s_waitcnt vmcnt(15)
    s_mov_b32 m0, s98
    s_add_u32 s65, s64, s98
    buffer_load_dwordx4 v11, s[12:15], s65 offen nt lds
    s_add_u32 s98, s98, 1024
    s_waitcnt vmcnt(15)
    s_mov_b32 m0, s98
    s_add_u32 s65, s64, s98
    buffer_load_dwordx4 v12, s[12:15], s65 offen nt lds
    s_add_u32 s98, s98, 1024
    s_waitcnt vmcnt(15)
    s_mov_b32 m0, s98
    s_add_u32 s65, s64, s98
    buffer_load_dwordx4 v13, s[12:15], s65 offen nt lds
    s_add_u32 s98, s98, 1024
    s_waitcnt vmcnt(15)
    s_and_b32 s98, s98, 0xffff
    s_sub_u32 s66, s66, 1
    s_cmp_lg_u32 s66, 0
    s_cbranch_scc1 L_km2
    s_branch L_ld_V
L_ld_W2:
    s_barrier
    s_cmp_eq_u32 s99, 0
    s_cbranch_scc0 L_ld_WQ

    s_add_u32 s59, s66, 26624
L_dw2:
    s_mov_b32 m0, s66
    s_add_u32 s66, s66, 1024
    buffer_load_dwordx4 v19, s[48:51], s42 offen nt lds
    s_add_u32 s42, s42, s67
    s_waitcnt vmcnt(11)
    s_mov_b32 m0, s66
    s_add_u32 s66, s66, 1024
    buffer_load_dwordx4 v20, s[48:51], s42 offen nt lds
    s_add_u32 s42, s42, s67
    s_waitcnt vmcnt(11)
    s_cmp_lt_u32 s66, s59
    s_cbranch_scc1 L_dw2

    s_mov_b32 s12, s18
    s_and_b32 s13, s19, 0xffff
    s_mov_b32 s14, 134217728
    s_mov_b32 s15, 0x20000
    s_mov_b32 s44, s20
    s_and_b32 s45, s21, 0xffff
    s_mov_b32 s46, 134217728
    s_mov_b32 s47, 0x20000
    v_lshlrev_b32 v4, 8, v2
    v_add_u32 v5, 0, v2
    v_xor_b32 v5, v5, v1
    v_lshl_add_u32 v10, v5, 4, v4
    v_add_u32 v5, 4, v2
    v_xor_b32 v5, v5, v1
    v_lshl_add_u32 v11, v5, 4, v4
    v_add_u32 v5, 8, v2
    v_xor_b32 v5, v5, v1
    v_lshl_add_u32 v12, v5, 4, v4
    v_add_u32 v5, 12, v2
    v_xor_b32 v5, v5, v1
    v_lshl_add_u32 v13, v5, 4, v4
    v_add_u32 v5, 0, v2
    v_lshlrev_b32 v5, 1, v5
    v_xor_b32 v5, v5, v1
    v_lshl_add_u32 v14, v5, 4, v4
    v_add_u32 v5, 4, v2
    v_lshlrev_b32 v5, 1, v5
    v_xor_b32 v5, v5, v1
    v_lshl_add_u32 v15, v5, 4, v4
    s_mul_i32 s98, s5, 5
    s_mul_i32 s57, s4, 3
    s_add_u32 s98, s98, s57
    s_and_b32 s98, s98, 15
    s_lshl_b32 s98, s98, 12
    s_mov_b32 s66, 2
L_k0:
    s_mov_b32 m0, s98
    s_add_u32 s65, s64, s98
    buffer_load_dwordx4 v10, s[12:15], s65 offen nt lds
    s_add_u32 s98, s98, 1024
    s_waitcnt vmcnt(15)
    s_mov_b32 m0, s98
    s_add_u32 s65, s64, s98
    buffer_load_dwordx4 v11, s[12:15], s65 offen nt lds
    s_add_u32 s98, s98, 1024
    s_waitcnt vmcnt(15)
    s_mov_b32 m0, s98
    s_add_u32 s65, s64, s98
    buffer_load_dwordx4 v12, s[12:15], s65 offen nt lds
    s_add_u32 s98, s98, 1024
    s_waitcnt vmcnt(15)
    s_mov_b32 m0, s98
    s_add_u32 s65, s64, s98
    buffer_load_dwordx4 v13, s[12:15], s65 offen nt lds
    s_add_u32 s98, s98, 1024
    s_waitcnt vmcnt(15)
    s_and_b32 s98, s98, 0xffff
    s_sub_u32 s66, s66, 1
    s_cmp_lg_u32 s66, 0
    s_cbranch_scc1 L_k0
    s_waitcnt vmcnt(8)
    v_mov_b32 v4, 131092
    v_mov_b32 v5, 1
    s_mov_b64 exec, 1
    ds_write_b32 v4, v5
    s_mov_b64 exec, -1
    s_mov_b32 s66, 6
L_k1m:
    s_mov_b32 m0, s98
    s_add_u32 s65, s64, s98
    buffer_load_dwordx4 v10, s[12:15], s65 offen nt lds
    s_add_u32 s98, s98, 1024
    s_waitcnt vmcnt(15)
    s_mov_b32 m0, s98
    s_add_u32 s65, s64, s98
    buffer_load_dwordx4 v11, s[12:15], s65 offen nt lds
    s_add_u32 s98, s98, 1024
    s_waitcnt vmcnt(15)
    s_mov_b32 m0, s98
    s_add_u32 s65, s64, s98
    buffer_load_dwordx4 v12, s[12:15], s65 offen nt lds
    s_add_u32 s98, s98, 1024
    s_waitcnt vmcnt(15)
    s_mov_b32 m0, s98
    s_add_u32 s65, s64, s98
    buffer_load_dwordx4 v13, s[12:15], s65 offen nt lds
    s_add_u32 s98, s98, 1024
    s_waitcnt vmcnt(15)
    s_and_b32 s98, s98, 0xffff
    s_sub_u32 s66, s66, 1
    s_cmp_lg_u32 s66, 0
    s_cbranch_scc1 L_k1m
    s_mov_b32 s66, 8
L_k1m2:
    s_mov_b32 m0, s98
    s_add_u32 s65, s64, s98
    buffer_load_dwordx4 v10, s[12:15], s65 offen nt lds
    s_add_u32 s98, s98, 1024
    s_waitcnt vmcnt(15)
    s_mov_b32 m0, s98
    s_add_u32 s65, s64, s98
    buffer_load_dwordx4 v11, s[12:15], s65 offen nt lds
    s_add_u32 s98, s98, 1024
    s_waitcnt vmcnt(15)
    s_mov_b32 m0, s98
    s_add_u32 s65, s64, s98
    buffer_load_dwordx4 v12, s[12:15], s65 offen nt lds
    s_add_u32 s98, s98, 1024
    s_waitcnt vmcnt(15)
    s_mov_b32 m0, s98
    s_add_u32 s65, s64, s98
    buffer_load_dwordx4 v13, s[12:15], s65 offen nt lds
    s_add_u32 s98, s98, 1024
    s_waitcnt vmcnt(15)
    s_and_b32 s98, s98, 0xffff
    s_sub_u32 s66, s66, 1
    s_cmp_lg_u32 s66, 0
    s_cbranch_scc1 L_k1m2
    s_branch L_ld_V
L_ld_WQ:
    s_add_u32 s59, s66, 26624
L_dwq:
    s_mov_b32 m0, s66
    s_add_u32 s66, s66, 1024
    buffer_load_dwordx4 v19, s[48:51], s42 offen nt lds
    s_add_u32 s42, s42, s67
    s_waitcnt vmcnt(11)
    s_mov_b32 m0, s66
    s_add_u32 s66, s66, 1024
    buffer_load_dwordx4 v20, s[48:51], s42 offen nt lds
    s_add_u32 s42, s42, s67
    s_waitcnt vmcnt(11)
    s_cmp_lt_u32 s66, s59
    s_cbranch_scc1 L_dwq

    s_mov_b32 s12, s18
    s_and_b32 s13, s19, 0xffff
    s_mov_b32 s14, 134217728
    s_mov_b32 s15, 0x20000
    s_mov_b32 s44, s20
    s_and_b32 s45, s21, 0xffff
    s_mov_b32 s46, 134217728
    s_mov_b32 s47, 0x20000
    v_lshlrev_b32 v4, 8, v2
    v_add_u32 v5, 0, v2
    v_xor_b32 v5, v5, v1
    v_lshl_add_u32 v10, v5, 4, v4
    v_add_u32 v5, 4, v2
    v_xor_b32 v5, v5, v1
    v_lshl_add_u32 v11, v5, 4, v4
    v_add_u32 v5, 8, v2
    v_xor_b32 v5, v5, v1
    v_lshl_add_u32 v12, v5, 4, v4
    v_add_u32 v5, 12, v2
    v_xor_b32 v5, v5, v1
    v_lshl_add_u32 v13, v5, 4, v4
    v_add_u32 v5, 0, v2
    v_lshlrev_b32 v5, 1, v5
    v_xor_b32 v5, v5, v1
    v_lshl_add_u32 v14, v5, 4, v4
    v_add_u32 v5, 4, v2
    v_lshlrev_b32 v5, 1, v5
    v_xor_b32 v5, v5, v1
    v_lshl_add_u32 v15, v5, 4, v4
    s_mul_i32 s98, s5, 5
    s_mul_i32 s57, s4, 3
    s_add_u32 s98, s98, s57
    s_and_b32 s98, s98, 15
    s_lshl_b32 s98, s98, 12
    s_mov_b32 s66, 2
L_k1:
    s_mov_b32 m0, s98
    s_add_u32 s65, s64, s98
    buffer_load_dwordx4 v10, s[12:15], s65 offen nt lds
    s_add_u32 s98, s98, 1024
    s_waitcnt vmcnt(15)
    s_mov_b32 m0, s98
    s_add_u32 s65, s64, s98
    buffer_load_dwordx4 v11, s[12:15], s65 offen nt lds
    s_add_u32 s98, s98, 1024
    s_waitcnt vmcnt(15)
    s_mov_b32 m0, s98
    s_add_u32 s65, s64, s98
    buffer_load_dwordx4 v12, s[12:15], s65 offen nt lds
    s_add_u32 s98, s98, 1024
    s_waitcnt vmcnt(15)
    s_mov_b32 m0, s98
    s_add_u32 s65, s64, s98
    buffer_load_dwordx4 v13, s[12:15], s65 offen nt lds
    s_add_u32 s98, s98, 1024
    s_waitcnt vmcnt(15)
    s_and_b32 s98, s98, 0xffff
    s_sub_u32 s66, s66, 1
    s_cmp_lg_u32 s66, 0
    s_cbranch_scc1 L_k1
    s_waitcnt vmcnt(8)
    v_mov_b32 v4, 131092
    v_mov_b32 v5, 1
    s_mov_b64 exec, 1
    ds_write_b32 v4, v5
    s_mov_b64 exec, -1
L_ld_K2:
    s_mov_b32 s66, 6
L_k2a:
    s_mov_b32 m0, s98
    s_add_u32 s65, s64, s98
    buffer_load_dwordx4 v10, s[12:15], s65 offen nt lds
    s_add_u32 s98, s98, 1024
    s_waitcnt vmcnt(15)
    s_mov_b32 m0, s98
    s_add_u32 s65, s64, s98
    buffer_load_dwordx4 v11, s[12:15], s65 offen nt lds
    s_add_u32 s98, s98, 1024
    s_waitcnt vmcnt(15)
    s_mov_b32 m0, s98
    s_add_u32 s65, s64, s98
    buffer_load_dwordx4 v12, s[12:15], s65 offen nt lds
    s_add_u32 s98, s98, 1024
    s_waitcnt vmcnt(15)
    s_mov_b32 m0, s98
    s_add_u32 s65, s64, s98
    buffer_load_dwordx4 v13, s[12:15], s65 offen nt lds
    s_add_u32 s98, s98, 1024
    s_waitcnt vmcnt(15)
    s_and_b32 s98, s98, 0xffff
    s_sub_u32 s66, s66, 1
    s_cmp_lg_u32 s66, 0
    s_cbranch_scc1 L_k2a
    s_mov_b32 s66, 8
L_k2:
    s_mov_b32 m0, s98
    s_add_u32 s65, s64, s98
    buffer_load_dwordx4 v10, s[12:15], s65 offen nt lds
    s_add_u32 s98, s98, 1024
    s_waitcnt vmcnt(15)
    s_mov_b32 m0, s98
    s_add_u32 s65, s64, s98
    buffer_load_dwordx4 v11, s[12:15], s65 offen nt lds
    s_add_u32 s98, s98, 1024
    s_waitcnt vmcnt(15)
    s_mov_b32 m0, s98
    s_add_u32 s65, s64, s98
    buffer_load_dwordx4 v12, s[12:15], s65 offen nt lds
    s_add_u32 s98, s98, 1024
    s_waitcnt vmcnt(15)
    s_mov_b32 m0, s98
    s_add_u32 s65, s64, s98
    buffer_load_dwordx4 v13, s[12:15], s65 offen nt lds
    s_add_u32 s98, s98, 1024
    s_waitcnt vmcnt(15)
    s_and_b32 s98, s98, 0xffff
    s_sub_u32 s66, s66, 1
    s_cmp_lg_u32 s66, 0
    s_cbranch_scc1 L_k2
    s_branch L_ld_V
L_ld_K0:
    s_barrier
    s_mov_b32 s12, s18
    s_and_b32 s13, s19, 0xffff
    s_mov_b32 s14, 134217728
    s_mov_b32 s15, 0x20000
    s_mov_b32 s44, s20
    s_and_b32 s45, s21, 0xffff
    s_mov_b32 s46, 134217728
    s_mov_b32 s47, 0x20000
    v_lshlrev_b32 v4, 8, v2
    v_add_u32 v5, 0, v2
    v_xor_b32 v5, v5, v1
    v_lshl_add_u32 v10, v5, 4, v4
    v_add_u32 v5, 4, v2
    v_xor_b32 v5, v5, v1
    v_lshl_add_u32 v11, v5, 4, v4
    v_add_u32 v5, 8, v2
    v_xor_b32 v5, v5, v1
    v_lshl_add_u32 v12, v5, 4, v4
    v_add_u32 v5, 12, v2
    v_xor_b32 v5, v5, v1
    v_lshl_add_u32 v13, v5, 4, v4
    v_add_u32 v5, 0, v2
    v_lshlrev_b32 v5, 1, v5
    v_xor_b32 v5, v5, v1
    v_lshl_add_u32 v14, v5, 4, v4
    v_add_u32 v5, 4, v2
    v_lshlrev_b32 v5, 1, v5
    v_xor_b32 v5, v5, v1
    v_lshl_add_u32 v15, v5, 4, v4
    s_mul_i32 s98, s5, 5
    s_mul_i32 s57, s4, 3
    s_add_u32 s98, s98, s57
    s_and_b32 s98, s98, 15
    s_lshl_b32 s98, s98, 12
    s_mov_b32 s66, 8
L_k3:
    s_mov_b32 m0, s98
    s_add_u32 s65, s64, s98
    buffer_load_dwordx4 v10, s[12:15], s65 offen nt lds
    s_add_u32 s98, s98, 1024
    s_waitcnt vmcnt(15)
    s_mov_b32 m0, s98
    s_add_u32 s65, s64, s98
    buffer_load_dwordx4 v11, s[12:15], s65 offen nt lds
    s_add_u32 s98, s98, 1024
    s_waitcnt vmcnt(15)
    s_mov_b32 m0, s98
    s_add_u32 s65, s64, s98
    buffer_load_dwordx4 v12, s[12:15], s65 offen nt lds
    s_add_u32 s98, s98, 1024
    s_waitcnt vmcnt(15)
    s_mov_b32 m0, s98
    s_add_u32 s65, s64, s98
    buffer_load_dwordx4 v13, s[12:15], s65 offen nt lds
    s_add_u32 s98, s98, 1024
    s_waitcnt vmcnt(15)
    s_and_b32 s98, s98, 0xffff
    s_sub_u32 s66, s66, 1
    s_cmp_lg_u32 s66, 0
    s_cbranch_scc1 L_k3
    s_mov_b32 s66, 8
L_k32:
    s_mov_b32 m0, s98
    s_add_u32 s65, s64, s98
    buffer_load_dwordx4 v10, s[12:15], s65 offen nt lds
    s_add_u32 s98, s98, 1024
    s_waitcnt vmcnt(15)
    s_mov_b32 m0, s98
    s_add_u32 s65, s64, s98
    buffer_load_dwordx4 v11, s[12:15], s65 offen nt lds
    s_add_u32 s98, s98, 1024
    s_waitcnt vmcnt(15)
    s_mov_b32 m0, s98
    s_add_u32 s65, s64, s98
    buffer_load_dwordx4 v12, s[12:15], s65 offen nt lds
    s_add_u32 s98, s98, 1024
    s_waitcnt vmcnt(15)
    s_mov_b32 m0, s98
    s_add_u32 s65, s64, s98
    buffer_load_dwordx4 v13, s[12:15], s65 offen nt lds
    s_add_u32 s98, s98, 1024
    s_waitcnt vmcnt(15)
    s_and_b32 s98, s98, 0xffff
    s_sub_u32 s66, s66, 1
    s_cmp_lg_u32 s66, 0
    s_cbranch_scc1 L_k32
L_ld_V:
    s_add_u32 s65, s64, 0
    s_mov_b32 s66, 65536
L_v0:
    s_mov_b32 m0, s66
    s_add_u32 s66, s66, 1024
    buffer_load_dwordx4 v14, s[44:47], s65 offen nt lds
    s_add_u32 s65, s65, 1024
    s_waitcnt vmcnt(25)
    s_mov_b32 m0, s66
    s_add_u32 s66, s66, 1024
    buffer_load_dwordx4 v15, s[44:47], s65 offen nt lds
    s_add_u32 s65, s65, 1024
    s_waitcnt vmcnt(25)
    s_cmp_lt_u32 s66, 92160
    s_cbranch_scc1 L_v0
    v_mov_b32 v4, 131088
    v_mov_b32 v5, 1
    s_mov_b64 exec, 1
    ds_write_b32 v4, v5
    s_mov_b64 exec, -1
    s_add_u32 s65, s64, 26624
    s_mov_b32 s66, 92160
L_v1:
    s_mov_b32 m0, s66
    s_add_u32 s66, s66, 1024
    buffer_load_dwordx4 v14, s[44:47], s65 offen nt lds
    s_add_u32 s65, s65, 1024
    s_waitcnt vmcnt(25)
    s_mov_b32 m0, s66
    s_add_u32 s66, s66, 1024
    buffer_load_dwordx4 v15, s[44:47], s65 offen nt lds
    s_add_u32 s65, s65, 1024
    s_waitcnt vmcnt(25)
    s_cmp_lt_u32 s66, 98304
    s_cbranch_scc1 L_v1
    s_cmp_eq_u32 s99, 2
    s_cbranch_scc1 L_ld_V2

    v_mov_b32 v4, 131084
    s_mov_b32 s63, 0
L_lw_49:
    ds_read_b32 v5, v4
    s_add_u32 s63, s63, 1
    s_cmp_gt_u32 s63, 200000
    s_cbranch_scc1 L_lwx_50
    s_waitcnt lgkmcnt(0)
    v_readfirstlane_b32 s56, v5
    s_cmp_ge_u32 s56, 8
    s_cbranch_scc0 L_lw_49
L_lwx_50:
    s_waitcnt lgkmcnt(0)
L_ld_V2:
    s_add_u32 s65, s64, 32768
    s_mov_b32 s66, 98304
L_v2:
    s_mov_b32 m0, s66
    s_add_u32 s66, s66, 1024
    buffer_load_dwordx4 v14, s[44:47], s65 offen nt lds
    s_add_u32 s65, s65, 1024
    s_waitcnt vmcnt(25)
    s_mov_b32 m0, s66
    s_add_u32 s66, s66, 1024
    buffer_load_dwordx4 v15, s[44:47], s65 offen nt lds
    s_add_u32 s65, s65, 1024
    s_waitcnt vmcnt(25)
    s_cmp_lt_u32 s66, 131072
    s_cbranch_scc1 L_v2
    s_waitcnt vmcnt(16)
    v_mov_b32 v4, 131100
    v_mov_b32 v5, 1
    s_mov_b64 exec, 1
    ds_write_b32 v4, v5
    s_mov_b64 exec, -1
    s_cmp_lt_u32 s5, 2
    s_cbranch_scc1 L_ld_M2
    s_cmp_lt_u32 s5, 8
    s_cbranch_scc1 L_ld_notail
    s_cmp_lt_u32 s5, 24
    s_cbranch_scc0 L_ld_F

    s_mov_b32 s48, s24
    s_and_b32 s49, s25, 0xffff
    s_mov_b32 s50, 4194304
    s_mov_b32 s51, 0x20000
    v_and_b32 v4, 1, v16
    v_lshlrev_b32 v4, 7, v4
    v_lshrrev_b32 v5, 1, v16
    v_add_u32 v4, v4, v5
    v_lshlrev_b32 v19, 10, v4
    v_add_u32 v19, v19, v17
    v_xor_b32 v20, 64, v19
    s_sub_u32 s42, s5, 8
    s_lshr_b32 s42, s42, 1
    s_lshl_b32 s42, s42, 7
    s_lshl_b32 s58, s4, 19
    s_add_u32 s42, s42, s58
    s_lshl_b32 s58, s62, 18
    s_add_u32 s42, s42, s58

    v_mov_b32 v4, 131080
    s_mov_b32 s63, 0
L_lw_51:
    ds_read_b32 v5, v4
    s_add_u32 s63, s63, 1
    s_cmp_gt_u32 s63, 200000
    s_cbranch_scc1 L_lwx_52
    s_waitcnt lgkmcnt(0)
    v_readfirstlane_b32 s56, v5
    s_cmp_ge_u32 s56, 8
    s_cbranch_scc0 L_lw_51
L_lwx_52:
    s_waitcnt lgkmcnt(0)
    s_mov_b32 s66, 0
    s_add_u32 s59, s66, 8192
L_do0:
    s_mov_b32 m0, s66
    s_add_u32 s66, s66, 1024
    buffer_load_dwordx4 v19, s[48:51], s42 offen nt lds
    s_add_u32 s42, s42, 4096
    s_mov_b32 m0, s66
    s_add_u32 s66, s66, 1024
    buffer_load_dwordx4 v20, s[48:51], s42 offen nt lds
    s_add_u32 s42, s42, 4096
    s_cmp_lt_u32 s66, s59
    s_cbranch_scc1 L_do0

    s_waitcnt vmcnt(8)
    s_barrier
    s_add_u32 s59, s66, 24576
L_do1:
    s_mov_b32 m0, s66
    s_add_u32 s66, s66, 1024
    buffer_load_dwordx4 v19, s[48:51], s42 offen nt lds
    s_add_u32 s42, s42, 4096
    s_waitcnt vmcnt(23)
    s_mov_b32 m0, s66
    s_add_u32 s66, s66, 1024
    buffer_load_dwordx4 v20, s[48:51], s42 offen nt lds
    s_add_u32 s42, s42, 4096
    s_waitcnt vmcnt(23)
    s_cmp_lt_u32 s66, s59
    s_cbranch_scc1 L_do1

    s_waitcnt vmcnt(0)
    v_mov_b32 v4, 131108
    v_mov_b32 v5, 1
    s_mov_b64 exec, 1
    ds_write_b32 v4, v5
    s_mov_b64 exec, -1
    s_branch L_ld_end
L_ld_F:
    s_sub_u32 s57, s5, 24
    s_lshl_b32 s58, s4, 3
    s_add_u32 s58, s58, s57
    s_mul_i32 s59, s4, 6
    s_add_u32 s59, s59, s57
    s_add_u32 s59, s59, 8
    s_cmp_lt_u32 s4, 4
    s_cselect_b32 s66, s58, s59
    s_cselect_b32 s58, 8, 6
    s_cmp_lt_u32 s57, s58
    s_cselect_b32 s66, s66, -1

    s_cmp_eq_u32 s66, -1
    s_cbranch_scc1 L_ld_notail
    s_mov_b32 s67, s66

    s_mov_b32 s48, s28
    s_and_b32 s49, s29, 0xffff
    s_mov_b32 s50, 1835008
    s_mov_b32 s51, 0x20000
    s_mov_b32 s52, s30
    s_and_b32 s53, s31, 0xffff
    s_mov_b32 s54, 1835008
    s_mov_b32 s55, 0x20000
    v_mul_u32_u24 v19, 3584, v16
    v_add_u32 v19, v19, v17
    v_xor_b32 v20, 64, v19
    s_lshr_b32 s42, s67, 1
    s_lshl_b32 s42, s42, 7
    s_mul_i32 s58, s62, 917504
    s_add_u32 s42, s42, s58
    s_mov_b32 s65, s42

    v_mov_b32 v4, 131080
    s_mov_b32 s63, 0
L_lw_53:
    ds_read_b32 v5, v4
    s_add_u32 s63, s63, 1
    s_cmp_gt_u32 s63, 200000
    s_cbranch_scc1 L_lwx_54
    s_waitcnt lgkmcnt(0)
    v_readfirstlane_b32 s56, v5
    s_cmp_ge_u32 s56, 8
    s_cbranch_scc0 L_lw_53
L_lwx_54:
    s_waitcnt lgkmcnt(0)
    s_mov_b32 s66, 0
    s_add_u32 s59, s66, 8192
L_df0:
    s_mov_b32 m0, s66
    s_add_u32 s66, s66, 1024
    buffer_load_dwordx4 v19, s[48:51], s42 offen nt lds
    s_add_u32 s42, s42, 28672
    s_mov_b32 m0, s66
    s_add_u32 s66, s66, 1024
    buffer_load_dwordx4 v20, s[48:51], s42 offen nt lds
    s_add_u32 s42, s42, 28672
    s_cmp_lt_u32 s66, s59
    s_cbranch_scc1 L_df0

    s_waitcnt vmcnt(8)
    s_barrier
    s_add_u32 s59, s66, 24576
L_df1:
    s_mov_b32 m0, s66
    s_add_u32 s66, s66, 1024
    buffer_load_dwordx4 v19, s[48:51], s42 offen nt lds
    s_add_u32 s42, s42, 28672
    s_waitcnt vmcnt(23)
    s_mov_b32 m0, s66
    s_add_u32 s66, s66, 1024
    buffer_load_dwordx4 v20, s[48:51], s42 offen nt lds
    s_add_u32 s42, s42, 28672
    s_waitcnt vmcnt(23)
    s_cmp_lt_u32 s66, s59
    s_cbranch_scc1 L_df1

    s_add_u32 s59, s66, 32768
L_du:
    s_mov_b32 m0, s66
    s_add_u32 s66, s66, 1024
    buffer_load_dwordx4 v19, s[52:55], s65 offen nt lds
    s_add_u32 s65, s65, 28672
    s_waitcnt vmcnt(31)
    s_mov_b32 m0, s66
    s_add_u32 s66, s66, 1024
    buffer_load_dwordx4 v20, s[52:55], s65 offen nt lds
    s_add_u32 s65, s65, 28672
    s_waitcnt vmcnt(31)
    s_cmp_lt_u32 s66, s59
    s_cbranch_scc1 L_du

    s_mov_b32 s48, s32
    s_and_b32 s49, s33, 0xffff
    s_mov_b32 s50, 1835008
    s_mov_b32 s51, 0x20000
    v_lshlrev_b32 v22, 4, v0
    s_lshl_b32 s65, s67, 15
    s_mov_b32 s66, 65536

    v_xor_b32 v21, 0, v22
    s_mov_b32 m0, s66
    s_add_u32 s66, s66, 1024
    buffer_load_dwordx4 v21, s[48:51], s65 offen nt lds
    s_add_u32 s65, s65, 1024
    v_xor_b32 v21, 32, v22
    s_mov_b32 m0, s66
    s_add_u32 s66, s66, 1024
    buffer_load_dwordx4 v21, s[48:51], s65 offen nt lds
    s_add_u32 s65, s65, 1024
    v_xor_b32 v21, 64, v22
    s_mov_b32 m0, s66
    s_add_u32 s66, s66, 1024
    buffer_load_dwordx4 v21, s[48:51], s65 offen nt lds
    s_add_u32 s65, s65, 1024
    v_xor_b32 v21, 96, v22
    s_mov_b32 m0, s66
    s_add_u32 s66, s66, 1024
    buffer_load_dwordx4 v21, s[48:51], s65 offen nt lds
    s_add_u32 s65, s65, 1024
    v_xor_b32 v21, 0, v22
    s_mov_b32 m0, s66
    s_add_u32 s66, s66, 1024
    buffer_load_dwordx4 v21, s[48:51], s65 offen nt lds
    s_add_u32 s65, s65, 1024
    v_xor_b32 v21, 32, v22
    s_mov_b32 m0, s66
    s_add_u32 s66, s66, 1024
    buffer_load_dwordx4 v21, s[48:51], s65 offen nt lds
    s_add_u32 s65, s65, 1024
    v_xor_b32 v21, 64, v22
    s_mov_b32 m0, s66
    s_add_u32 s66, s66, 1024
    buffer_load_dwordx4 v21, s[48:51], s65 offen nt lds
    s_add_u32 s65, s65, 1024
    v_xor_b32 v21, 96, v22
    s_mov_b32 m0, s66
    s_add_u32 s66, s66, 1024
    buffer_load_dwordx4 v21, s[48:51], s65 offen nt lds
    s_add_u32 s65, s65, 1024
    s_waitcnt vmcnt(8)
    v_mov_b32 v4, 131108
    v_mov_b32 v5, 1
    s_mov_b64 exec, 1
    ds_write_b32 v4, v5
    s_mov_b64 exec, -1
    v_xor_b32 v21, 128, v22
    s_mov_b32 m0, s66
    s_add_u32 s66, s66, 1024
    buffer_load_dwordx4 v21, s[48:51], s65 offen nt lds
    s_add_u32 s65, s65, 1024
    s_waitcnt vmcnt(31)
    v_xor_b32 v21, 160, v22
    s_mov_b32 m0, s66
    s_add_u32 s66, s66, 1024
    buffer_load_dwordx4 v21, s[48:51], s65 offen nt lds
    s_add_u32 s65, s65, 1024
    s_waitcnt vmcnt(31)
    v_xor_b32 v21, 192, v22
    s_mov_b32 m0, s66
    s_add_u32 s66, s66, 1024
    buffer_load_dwordx4 v21, s[48:51], s65 offen nt lds
    s_add_u32 s65, s65, 1024
    s_waitcnt vmcnt(31)
    v_xor_b32 v21, 224, v22
    s_mov_b32 m0, s66
    s_add_u32 s66, s66, 1024
    buffer_load_dwordx4 v21, s[48:51], s65 offen nt lds
    s_add_u32 s65, s65, 1024
    s_waitcnt vmcnt(31)
    v_xor_b32 v21, 128, v22
    s_mov_b32 m0, s66
    s_add_u32 s66, s66, 1024
    buffer_load_dwordx4 v21, s[48:51], s65 offen nt lds
    s_add_u32 s65, s65, 1024
    s_waitcnt vmcnt(31)
    v_xor_b32 v21, 160, v22
    s_mov_b32 m0, s66
    s_add_u32 s66, s66, 1024
    buffer_load_dwordx4 v21, s[48:51], s65 offen nt lds
    s_add_u32 s65, s65, 1024
    s_waitcnt vmcnt(31)
    v_xor_b32 v21, 192, v22
    s_mov_b32 m0, s66
    s_add_u32 s66, s66, 1024
    buffer_load_dwordx4 v21, s[48:51], s65 offen nt lds
    s_add_u32 s65, s65, 1024
    s_waitcnt vmcnt(31)
    v_xor_b32 v21, 224, v22
    s_mov_b32 m0, s66
    s_add_u32 s66, s66, 1024
    buffer_load_dwordx4 v21, s[48:51], s65 offen nt lds
    s_add_u32 s65, s65, 1024
    s_waitcnt vmcnt(31)
    v_xor_b32 v21, 0, v22
    s_mov_b32 m0, s66
    s_add_u32 s66, s66, 1024
    buffer_load_dwordx4 v21, s[48:51], s65 offen nt lds
    s_add_u32 s65, s65, 1024
    s_waitcnt vmcnt(31)
    v_xor_b32 v21, 32, v22
    s_mov_b32 m0, s66
    s_add_u32 s66, s66, 1024
    buffer_load_dwordx4 v21, s[48:51], s65 offen nt lds
    s_add_u32 s65, s65, 1024
    s_waitcnt vmcnt(31)
    v_xor_b32 v21, 64, v22
    s_mov_b32 m0, s66
    s_add_u32 s66, s66, 1024
    buffer_load_dwordx4 v21, s[48:51], s65 offen nt lds
    s_add_u32 s65, s65, 1024
    s_waitcnt vmcnt(31)
    v_xor_b32 v21, 96, v22
    s_mov_b32 m0, s66
    s_add_u32 s66, s66, 1024
    buffer_load_dwordx4 v21, s[48:51], s65 offen nt lds
    s_add_u32 s65, s65, 1024
    s_waitcnt vmcnt(31)
    v_xor_b32 v21, 0, v22
    s_mov_b32 m0, s66
    s_add_u32 s66, s66, 1024
    buffer_load_dwordx4 v21, s[48:51], s65 offen nt lds
    s_add_u32 s65, s65, 1024
    s_waitcnt vmcnt(31)
    v_xor_b32 v21, 32, v22
    s_mov_b32 m0, s66
    s_add_u32 s66, s66, 1024
    buffer_load_dwordx4 v21, s[48:51], s65 offen nt lds
    s_add_u32 s65, s65, 1024
    s_waitcnt vmcnt(31)
    v_xor_b32 v21, 64, v22
    s_mov_b32 m0, s66
    s_add_u32 s66, s66, 1024
    buffer_load_dwordx4 v21, s[48:51], s65 offen nt lds
    s_add_u32 s65, s65, 1024
    s_waitcnt vmcnt(31)
    v_xor_b32 v21, 96, v22
    s_mov_b32 m0, s66
    s_add_u32 s66, s66, 1024
    buffer_load_dwordx4 v21, s[48:51], s65 offen nt lds
    s_add_u32 s65, s65, 1024
    s_waitcnt vmcnt(31)
    v_xor_b32 v21, 128, v22
    s_mov_b32 m0, s66
    s_add_u32 s66, s66, 1024
    buffer_load_dwordx4 v21, s[48:51], s65 offen nt lds
    s_add_u32 s65, s65, 1024
    s_waitcnt vmcnt(31)
    v_xor_b32 v21, 160, v22
    s_mov_b32 m0, s66
    s_add_u32 s66, s66, 1024
    buffer_load_dwordx4 v21, s[48:51], s65 offen nt lds
    s_add_u32 s65, s65, 1024
    s_waitcnt vmcnt(31)
    v_xor_b32 v21, 192, v22
    s_mov_b32 m0, s66
    s_add_u32 s66, s66, 1024
    buffer_load_dwordx4 v21, s[48:51], s65 offen nt lds
    s_add_u32 s65, s65, 1024
    s_waitcnt vmcnt(31)
    v_xor_b32 v21, 224, v22
    s_mov_b32 m0, s66
    s_add_u32 s66, s66, 1024
    buffer_load_dwordx4 v21, s[48:51], s65 offen nt lds
    s_add_u32 s65, s65, 1024
    s_waitcnt vmcnt(31)
    v_xor_b32 v21, 128, v22
    s_mov_b32 m0, s66
    s_add_u32 s66, s66, 1024
    buffer_load_dwordx4 v21, s[48:51], s65 offen nt lds
    s_add_u32 s65, s65, 1024
    s_waitcnt vmcnt(31)
    v_xor_b32 v21, 160, v22
    s_mov_b32 m0, s66
    s_add_u32 s66, s66, 1024
    buffer_load_dwordx4 v21, s[48:51], s65 offen nt lds
    s_add_u32 s65, s65, 1024
    s_waitcnt vmcnt(31)
    v_xor_b32 v21, 192, v22
    s_mov_b32 m0, s66
    s_add_u32 s66, s66, 1024
    buffer_load_dwordx4 v21, s[48:51], s65 offen nt lds
    s_add_u32 s65, s65, 1024
    s_waitcnt vmcnt(31)
    v_xor_b32 v21, 224, v22
    s_mov_b32 m0, s66
    s_add_u32 s66, s66, 1024
    buffer_load_dwordx4 v21, s[48:51], s65 offen nt lds
    s_add_u32 s65, s65, 1024
    s_waitcnt vmcnt(31)
    s_waitcnt vmcnt(0)
    v_mov_b32 v4, 131112
    v_mov_b32 v5, 1
    s_mov_b64 exec, 1
    ds_write_b32 v4, v5
    s_mov_b64 exec, -1
    s_branch L_ld_end
L_ld_M2:
    s_mov_b32 s48, s36
    s_and_b32 s49, s37, 0xffff
    s_mov_b32 s50, 3145728
    s_mov_b32 s51, 0x20000
    v_mul_u32_u24 v19, 6144, v16
    v_add_u32 v19, v19, v17
    v_xor_b32 v20, 64, v19

    s_lshl_b32 s57, s4, 1
    s_add_u32 s57, s57, s5
    s_add_u32 s57, s57, 80
    s_lshr_b32 s42, s57, 1

    s_lshl_b32 s42, s42, 7
    s_mul_i32 s58, s62, 1572864
    s_add_u32 s42, s42, s58

    s_waitcnt vmcnt(0)
    s_barrier
    v_mov_b32 v4, 131132
    s_mov_b32 s63, 0
L_lw_55:
    ds_read_b32 v5, v4
    s_add_u32 s63, s63, 1
    s_cmp_gt_u32 s63, 200000
    s_cbranch_scc1 L_lwx_56
    s_waitcnt lgkmcnt(0)
    v_readfirstlane_b32 s56, v5
    s_cmp_ge_u32 s56, 1
    s_cbranch_scc0 L_lw_55
L_lwx_56:
    s_waitcnt lgkmcnt(0)
    s_mov_b32 s66, 0
    s_add_u32 s59, s66, 32768
L_dm1:
    s_mov_b32 m0, s66
    s_add_u32 s66, s66, 1024
    buffer_load_dwordx4 v19, s[48:51], s42 offen nt lds
    s_add_u32 s42, s42, 49152
    s_mov_b32 m0, s66
    s_add_u32 s66, s66, 1024
    buffer_load_dwordx4 v20, s[48:51], s42 offen nt lds
    s_add_u32 s42, s42, 49152
    s_cmp_lt_u32 s66, s59
    s_cbranch_scc1 L_dm1

    s_waitcnt vmcnt(0)
    v_mov_b32 v4, 131108
    v_mov_b32 v5, 1
    s_mov_b64 exec, 1
    ds_write_b32 v4, v5
    s_mov_b64 exec, -1
    s_branch L_ld_end
L_ld_notail:
    s_waitcnt vmcnt(0)
    s_barrier
L_ld_end:
    s_endpgm
L_notloader:
    s_cmp_eq_u32 s3, 9
    s_cbranch_scc1 L_aux

    s_lshl_b32 s57, s3, 9
    s_add_u32 s67, s57, 135168
    v_mov_b32 v9, s67
    v_lshl_add_u32 v9, v1, 2, v9
    v_lshrrev_b32 v8, 5, v0
    v_lshlrev_b32 v16, 8, v8
    v_and_b32 v17, 31, v0
    v_lshl_add_u32 v16, v17, 3, v16
    v_add_u32 v16, 135168, v16
    s_lshl_b32 s57, s3, 8
    s_add_u32 s57, s57, 133120
    v_lshlrev_b32 v10, 6, v8
    v_lshl_add_u32 v10, v1, 2, v10
    v_add_u32 v10, s57, v10
    v_and_b32 v11, 1, v0
    v_lshlrev_b32 v11, 6, v11
    v_lshl_add_u32 v11, v2, 4, v11
    v_add_u32 v11, s57, v11
    s_cmp_eq_u32 s99, 0
    s_cbranch_scc1 L_M_role
    s_cmp_eq_u32 s99, 1
    s_cbranch_scc0 L_role_none

    v_lshrrev_b32 v4, 5, v0
    v_and_b32 v5, 31, v0
    v_lshlrev_b32 v6, 10, v4
    v_lshl_add_u32 v7, v5, 5, v6
    s_waitcnt lgkmcnt(0)
    s_load_dword s6, s[40:41], 0

    s_mov_b32 s44, s16
    s_and_b32 s45, s17, 0xffff
    s_mov_b32 s46, 2048
    s_mov_b32 s47, 0x20000
    buffer_load_dwordx4 v[58:61], v7, s[44:47], 0 offen
    buffer_load_dwordx4 v[62:65], v7, s[44:47], 0 offen offset:16
    v_lshl_add_u32 v7, v1, 2, v6
    s_lshl_b32 s57, s62, 9
    s_lshl_b32 s58, s3, 6
    s_add_u32 s57, s57, s58
    buffer_load_dword v66, v7, s[44:47], s57 offen
    s_barrier

    s_mov_b32 s8, s40
    s_and_b32 s9, s41, 0xffff
    s_mov_b32 s10, 2097152
    s_mov_b32 s11, 0x20000
    s_waitcnt lgkmcnt(0)
    s_add_u32 s6, s6, 2654435769
    v_mov_b32 v3, s6
    s_waitcnt vmcnt(1)

    v_lshlrev_b32 v68, 16, v58
    v_and_b32 v69, s68, v58
    v_lshlrev_b32 v70, 16, v59
    v_and_b32 v71, s68, v59
    v_lshlrev_b32 v72, 16, v60
    v_and_b32 v73, s68, v60
    v_lshlrev_b32 v74, 16, v61
    v_and_b32 v75, s68, v61
    v_lshlrev_b32 v76, 16, v62
    v_and_b32 v77, s68, v62
    v_lshlrev_b32 v78, 16, v63
    v_and_b32 v79, s68, v63
    v_lshlrev_b32 v80, 16, v64
    v_and_b32 v81, s68, v64
    v_lshlrev_b32 v82, 16, v65
    v_and_b32 v83, s68, v65
    v_pk_add_f32 v[84:85], v[68:69], v[70:71]
    v_pk_add_f32 v[84:85], v[84:85], v[72:73]
    v_pk_add_f32 v[84:85], v[84:85], v[74:75]
    v_pk_add_f32 v[84:85], v[84:85], v[76:77]
    v_pk_add_f32 v[84:85], v[84:85], v[78:79]
    v_pk_add_f32 v[84:85], v[84:85], v[80:81]
    v_pk_add_f32 v[84:85], v[84:85], v[82:83]
    v_add_f32 v84, v84, v85
    s_nop 1
    v_add_f32_dpp v84, v84, v84 quad_perm:[1,0,3,2] row_mask:0xf bank_mask:0xf
    s_nop 1
    v_add_f32_dpp v84, v84, v84 quad_perm:[2,3,0,1] row_mask:0xf bank_mask:0xf
    s_nop 1
    v_add_f32_dpp v84, v84, v84 row_half_mirror row_mask:0xf bank_mask:0xf
    s_nop 1
    v_add_f32_dpp v84, v84, v84 row_ror:8 row_mask:0xf bank_mask:0xf
    v_mov_b32 v85, v84
    s_nop 1
    v_permlane16_swap_b32 v84, v85
    v_add_f32 v84, v84, v85
    v_mul_f32 v84, 0x3b000000, v84
    v_mov_b32 v86, 0
    v_sub_f32 v87, v68, v84
    v_fmac_f32 v86, v87, v87
    v_sub_f32 v87, v69, v84
    v_fmac_f32 v86, v87, v87
    v_sub_f32 v87, v70, v84
    v_fmac_f32 v86, v87, v87
    v_sub_f32 v87, v71, v84
    v_fmac_f32 v86, v87, v87
    v_sub_f32 v87, v72, v84
    v_fmac_f32 v86, v87, v87
    v_sub_f32 v87, v73, v84
    v_fmac_f32 v86, v87, v87
    v_sub_f32 v87, v74, v84
    v_fmac_f32 v86, v87, v87
    v_sub_f32 v87, v75, v84
    v_fmac_f32 v86, v87, v87
    v_sub_f32 v87, v76, v84
    v_fmac_f32 v86, v87, v87
    v_sub_f32 v87, v77, v84
    v_fmac_f32 v86, v87, v87
    v_sub_f32 v87, v78, v84
    v_fmac_f32 v86, v87, v87
    v_sub_f32 v87, v79, v84
    v_fmac_f32 v86, v87, v87
    v_sub_f32 v87, v80, v84
    v_fmac_f32 v86, v87, v87
    v_sub_f32 v87, v81, v84
    v_fmac_f32 v86, v87, v87
    v_sub_f32 v87, v82, v84
    v_fmac_f32 v86, v87, v87
    v_sub_f32 v87, v83, v84
    v_fmac_f32 v86, v87, v87
    s_nop 1
    v_add_f32_dpp v86, v86, v86 quad_perm:[1,0,3,2] row_mask:0xf bank_mask:0xf
    s_nop 1
    v_add_f32_dpp v86, v86, v86 quad_perm:[2,3,0,1] row_mask:0xf bank_mask:0xf
    s_nop 1
    v_add_f32_dpp v86, v86, v86 row_half_mirror row_mask:0xf bank_mask:0xf
    s_nop 1
    v_add_f32_dpp v86, v86, v86 row_ror:8 row_mask:0xf bank_mask:0xf
    v_mov_b32 v85, v86
    s_nop 1
    v_permlane16_swap_b32 v86, v85
    v_add_f32 v86, v86, v85
    v_mul_f32 v86, 0x3b000000, v86
    v_cvt_pk_bf16_f32 v85, v84, v86
    v_lshlrev_b32 v88, 16, v85
    v_and_b32 v89, s68, v85
    v_add_f32 v89, 0x3727c5ac, v89
    v_cvt_pk_bf16_f32 v85, v89, v89
    v_lshlrev_b32 v89, 16, v85
    v_sqrt_f32 v89, v89
    s_nop 0
    v_cvt_pk_bf16_f32 v85, v89, v89
    v_lshlrev_b32 v89, 16, v85
    v_rcp_f32 v90, v89
    s_nop 0
    s_waitcnt vmcnt(0)
    v_lshlrev_b32 v92, 16, v66
    v_and_b32 v93, s68, v66
    v_sub_f32 v92, v92, v88
    v_sub_f32 v93, v93, v88
    v_cvt_pk_bf16_f32 v84, v92, v93
    v_lshlrev_b32 v92, 16, v84
    v_and_b32 v93, s68, v84
    v_mul_f32 v80, v92, v90
    v_mul_f32 v81, v93, v90
    v_fma_f32 v82, -v80, v89, v92
    v_fma_f32 v83, -v81, v89, v93
    v_fma_f32 v92, v82, v90, v80
    v_fma_f32 v93, v83, v90, v81
    v_cvt_pk_bf16_f32 v84, v92, v93
    v_lshlrev_b32 v92, 16, v84
    v_and_b32 v93, s68, v84
    v_lshrrev_b32 v12, 2, v1
    v_lshrrev_b32 v13, 1, v12
    v_and_b32 v14, 1, v2
    v_lshl_add_u32 v13, v14, 1, v13
    v_lshl_add_u32 v12, v2, 3, v12
    v_lshlrev_b32 v12, 7, v12
    v_lshl_add_u32 v12, v13, 5, v12
    v_and_b32 v13, 3, v0
    v_lshl_add_u32 v12, v13, 3, v12
    s_lshl_b32 s57, s3, 12
    s_add_u32 s57, s57, 98304
    v_add_u32 v12, s57, v12
    v_xor_b32 v13, 32, v12
    v_xor_b32 v14, 64, v12
    v_xor_b32 v15, 96, v12
    v_lshrrev_b32 v17, 5, v0
    v_lshlrev_b32 v17, 15, v17
    v_and_b32 v5, 31, v0
    v_lshl_add_u32 v17, v5, 4, v17
    s_lshl_b32 s57, s4, 8
    s_sub_u32 s58, s5, 8
    s_lshr_b32 s58, s58, 1
    s_lshl_b32 s58, s58, 5
    s_add_u32 s57, s57, s58
    s_lshl_b32 s57, s57, 4
    s_lshl_b32 s58, s62, 16
    s_add_u32 s57, s57, s58
    s_add_u32 s66, s57, 131072

    v_mov_b32 v4, 131092
    s_mov_b32 s63, 0
L_lw_1:
    ds_read_b32 v5, v4
    s_add_u32 s63, s63, 1
    s_cmp_gt_u32 s63, 200000
    s_cbranch_scc1 L_lwx_2
    s_waitcnt lgkmcnt(0)
    v_readfirstlane_b32 s56, v5
    s_cmp_ge_u32 s56, 1
    s_cbranch_scc0 L_lw_1
L_lwx_2:
    s_waitcnt lgkmcnt(0)
    ds_read_b64_tr_b16 v[26:27], v12 offset:0
    ds_read_b64_tr_b16 v[28:29], v12 offset:512
    ds_read_b64_tr_b16 v[30:31], v13 offset:0
    ds_read_b64_tr_b16 v[32:33], v13 offset:512
    ds_read_b64_tr_b16 v[34:35], v14 offset:0
    ds_read_b64_tr_b16 v[36:37], v14 offset:512
    ds_read_b64_tr_b16 v[38:39], v15 offset:0
    ds_read_b64_tr_b16 v[40:41], v15 offset:512
    s_waitcnt lgkmcnt(0)
    v_mov_b32 v4, 131084
    v_mov_b32 v5, 1
    s_mov_b64 exec, 1
    ds_add_u32 v4, v5
    s_mov_b64 exec, -1
    v_lshrrev_b32 v4, 5, v0
    v_mul_u32_u24 v4, 24576, v4
    v_and_b32 v5, 1, v2
    v_mul_u32_u24 v5, 49152, v5
    v_add_u32 v4, v4, v5
    v_lshl_add_u32 v4, v1, 4, v4
    s_lshl_b32 s57, s62, 11
    s_lshl_b32 s58, s3, 8
    s_add_u32 s57, s57, s58
    s_add_u32 s64, s57, 8192
    s_add_u32 s65, s57, 12288

    s_mov_b32 s63, 0
L_pl_3:
    buffer_load_dwordx4 v[68:71], v4, s[8:11], s64 offen sc1
    buffer_load_dwordx4 v[72:75], v4, s[8:11], s65 offen sc1
    s_add_u32 s63, s63, 1
    s_cmp_gt_u32 s63, 200000
    s_cbranch_scc1 L_plx_4
    s_waitcnt vmcnt(0)
    v_xor_b32 v76, v70, v3
    v_bitop3_b32 v76, v76, v74, v3 bitop3:0xf6
    v_cmp_ne_u32 vcc, 0, v76
    s_cbranch_vccnz L_pl_3
L_plx_4:
    s_waitcnt vmcnt(0)
    v_mov_b32 v6, 131116
    ds_read_b32 v6, v6
    v_mov_b32 v80, v68
    v_mov_b32 v81, v69
    s_nop 1
    v_permlane16_swap_b32 v68, v80
    v_permlane16_swap_b32 v69, v81
    v_add_f32 v68, v68, v80
    v_add_f32 v69, v69, v81
    v_mov_b32 v80, v72
    v_mov_b32 v81, v73
    s_nop 1
    v_permlane16_swap_b32 v72, v80
    v_permlane16_swap_b32 v73, v81
    v_add_f32 v72, v72, v80
    v_add_f32 v73, v73, v81
    v_mov_b32 v76, v68
    v_mov_b32 v77, v69
    v_cvt_pk_bf16_f32 v80, v76, v77
    v_lshlrev_b32 v76, 16, v80
    v_and_b32 v77, s68, v80
    v_cvt_pk_bf16_f32 v80, v72, v73
    v_lshlrev_b32 v72, 16, v80
    v_and_b32 v73, s68, v80
    v_add_f32 v78, 1.0, v72
    v_add_f32 v79, 1.0, v73
    v_cvt_pk_bf16_f32 v80, v78, v79
    v_lshlrev_b32 v78, 16, v80
    v_and_b32 v79, s68, v80
    v_mul_f32 v92, v92, v78
    v_mul_f32 v93, v93, v79
    v_cvt_pk_bf16_f32 v80, v92, v93
    v_lshlrev_b32 v92, 16, v80
    v_and_b32 v93, s68, v80
    v_add_f32 v92, v92, v76
    v_add_f32 v93, v93, v77
    v_cvt_pk_bf16_f32 v67, v92, v93
    ds_write_b32 v10, v67
    ds_read_b128 v[42:45], v11
    s_waitcnt lgkmcnt(0)

    v_readfirstlane_b32 s43, v6
    v_mfma_f32_16x16x32_bf16 v[50:53], v[42:45], v[26:29], 0
    v_mfma_f32_16x16x32_bf16 v[54:57], v[42:45], v[30:33], 0
    v_mfma_f32_16x16x32_bf16 v[58:61], v[42:45], v[34:37], 0
    v_mfma_f32_16x16x32_bf16 v[62:65], v[42:45], v[38:41], 0
    s_nop 7
    s_mov_b64 exec, 0xffff
    ds_write2_b32 v9, v50, v54 offset0:0 offset1:16
    ds_write2_b32 v9, v58, v62 offset0:32 offset1:48
    ds_write2_b32 v9, v51, v55 offset0:64 offset1:80
    ds_write2_b32 v9, v59, v63 offset0:96 offset1:112
    s_mov_b64 exec, -1
    v_mov_b32 v4, 131072
    v_mov_b32 v5, 1
    s_mov_b64 exec, 1
    ds_add_rtn_u32 v5, v4, v5
    s_mov_b64 exec, -1
    s_waitcnt lgkmcnt(0)
    v_readfirstlane_b32 s56, v5
    s_cmp_eq_u32 s56, 7
    s_cbranch_scc0 L_attn
    ds_read_b64 v[68:69], v16 offset:0
    ds_read_b64 v[70:71], v16 offset:512
    ds_read_b64 v[72:73], v16 offset:1024
    ds_read_b64 v[74:75], v16 offset:1536
    ds_read_b64 v[76:77], v16 offset:2048
    ds_read_b64 v[78:79], v16 offset:2560
    ds_read_b64 v[80:81], v16 offset:3072
    ds_read_b64 v[82:83], v16 offset:3584
    s_waitcnt lgkmcnt(0)
    v_pk_add_f32 v[68:69], v[68:69], v[70:71]
    v_pk_add_f32 v[72:73], v[72:73], v[74:75]
    v_pk_add_f32 v[76:77], v[76:77], v[78:79]
    v_pk_add_f32 v[80:81], v[80:81], v[82:83]
    v_pk_add_f32 v[68:69], v[68:69], v[72:73]
    v_pk_add_f32 v[76:77], v[76:77], v[80:81]
    v_pk_add_f32 v[68:69], v[68:69], v[76:77]
    v_mov_b32 v70, v3
    v_mov_b32 v71, 0

    s_cmp_eq_u32 s43, 2
    s_cbranch_scc0 L_ls_5
    buffer_store_dwordx4 v[68:71], v17, s[8:11], s66 offen
L_lb_6:
    v_mov_b32 v4, 131104
    v_mov_b32 v5, 1
    s_mov_b64 exec, 1
    ds_write_b32 v4, v5
    s_mov_b64 exec, -1
    s_branch L_attn
L_M_role:
    v_and_b32 v4, 1, v0
    v_lshlrev_b32 v4, 10, v4
    v_lshl_add_u32 v7, v2, 4, v4
    s_lshl_b32 s57, s62, 9
    s_lshl_b32 s58, s3, 6
    s_add_u32 s64, s57, s58
    s_waitcnt lgkmcnt(0)
    s_load_dword s6, s[40:41], 0

    s_mov_b32 s44, s34
    s_and_b32 s45, s35, 0xffff
    s_mov_b32 s46, 2048
    s_mov_b32 s47, 0x20000
    buffer_load_dwordx4 v[42:45], v7, s[44:47], s64 offen
    s_barrier

    s_mov_b32 s8, s40
    s_and_b32 s9, s41, 0xffff
    s_mov_b32 s10, 2097152
    s_mov_b32 s11, 0x20000
    s_lshl_b32 s57, s4, 3
    s_add_u32 s57, s57, s5
    s_lshl_b32 s58, s4, 2
    s_add_u32 s58, s58, s5
    s_add_u32 s58, s58, 40
    s_cmp_lt_u32 s5, 8
    s_cselect_b32 s57, s57, s58
    s_lshr_b32 s66, s57, 1

    s_waitcnt lgkmcnt(0)
    s_add_u32 s6, s6, 2654435769
    v_mov_b32 v3, s6
    s_waitcnt vmcnt(0)

    v_lshlrev_b32 v58, 16, v42
    v_and_b32 v59, s68, v42
    v_mul_f32 v60, 0xbfb8aa3b, v58
    v_mul_f32 v61, 0xbfb8aa3b, v59
    v_exp_f32 v60, v60
    v_exp_f32 v61, v61
    s_nop 0
    v_add_f32 v60, 1.0, v60
    v_add_f32 v61, 1.0, v61
    v_rcp_f32 v60, v60
    v_rcp_f32 v61, v61
    s_nop 0
    v_mul_f32 v58, v58, v60
    v_mul_f32 v59, v59, v61
    v_cvt_pk_bf16_f32 v42, v58, v59
    v_lshlrev_b32 v58, 16, v43
    v_and_b32 v59, s68, v43
    v_mul_f32 v60, 0xbfb8aa3b, v58
    v_mul_f32 v61, 0xbfb8aa3b, v59
    v_exp_f32 v60, v60
    v_exp_f32 v61, v61
    s_nop 0
    v_add_f32 v60, 1.0, v60
    v_add_f32 v61, 1.0, v61
    v_rcp_f32 v60, v60
    v_rcp_f32 v61, v61
    s_nop 0
    v_mul_f32 v58, v58, v60
    v_mul_f32 v59, v59, v61
    v_cvt_pk_bf16_f32 v43, v58, v59
    v_lshlrev_b32 v58, 16, v44
    v_and_b32 v59, s68, v44
    v_mul_f32 v60, 0xbfb8aa3b, v58
    v_mul_f32 v61, 0xbfb8aa3b, v59
    v_exp_f32 v60, v60
    v_exp_f32 v61, v61
    s_nop 0
    v_add_f32 v60, 1.0, v60
    v_add_f32 v61, 1.0, v61
    v_rcp_f32 v60, v60
    v_rcp_f32 v61, v61
    s_nop 0
    v_mul_f32 v58, v58, v60
    v_mul_f32 v59, v59, v61
    v_cvt_pk_bf16_f32 v44, v58, v59
    v_lshlrev_b32 v58, 16, v45
    v_and_b32 v59, s68, v45
    v_mul_f32 v60, 0xbfb8aa3b, v58
    v_mul_f32 v61, 0xbfb8aa3b, v59
    v_exp_f32 v60, v60
    v_exp_f32 v61, v61
    s_nop 0
    v_add_f32 v60, 1.0, v60
    v_add_f32 v61, 1.0, v61
    v_rcp_f32 v60, v60
    v_rcp_f32 v61, v61
    s_nop 0
    v_mul_f32 v58, v58, v60
    v_mul_f32 v59, v59, v61
    v_cvt_pk_bf16_f32 v45, v58, v59
    v_lshrrev_b32 v12, 2, v1
    v_lshrrev_b32 v13, 1, v12
    v_and_b32 v14, 1, v2
    v_lshl_add_u32 v13, v14, 1, v13
    v_lshl_add_u32 v12, v2, 3, v12
    v_lshlrev_b32 v12, 7, v12
    v_lshl_add_u32 v12, v13, 5, v12
    v_and_b32 v13, 3, v0
    v_lshl_add_u32 v12, v13, 3, v12
    s_lshl_b32 s57, s3, 12
    s_add_u32 s57, s57, 98304
    v_add_u32 v12, s57, v12
    v_xor_b32 v13, 32, v12
    v_xor_b32 v14, 64, v12
    v_xor_b32 v15, 96, v12
    v_lshrrev_b32 v17, 5, v0
    v_mul_u32_u24 v17, 24576, v17
    v_and_b32 v5, 31, v0
    v_lshl_add_u32 v17, v5, 4, v17
    s_lshl_b32 s57, s66, 9
    s_mul_i32 s58, s62, 49152
    s_add_u32 s57, s57, s58
    s_add_u32 s66, s57, 8192

    v_mov_b32 v4, 131092
    s_mov_b32 s63, 0
L_lw_7:
    ds_read_b32 v5, v4
    s_add_u32 s63, s63, 1
    s_cmp_gt_u32 s63, 200000
    s_cbranch_scc1 L_lwx_8
    s_waitcnt lgkmcnt(0)
    v_readfirstlane_b32 s56, v5
    s_cmp_ge_u32 s56, 1
    s_cbranch_scc0 L_lw_7
L_lwx_8:
    s_waitcnt lgkmcnt(0)
    ds_read_b64_tr_b16 v[26:27], v12 offset:0
    ds_read_b64_tr_b16 v[28:29], v12 offset:512
    ds_read_b64_tr_b16 v[30:31], v13 offset:0
    ds_read_b64_tr_b16 v[32:33], v13 offset:512
    ds_read_b64_tr_b16 v[34:35], v14 offset:0
    ds_read_b64_tr_b16 v[36:37], v14 offset:512
    ds_read_b64_tr_b16 v[38:39], v15 offset:0
    ds_read_b64_tr_b16 v[40:41], v15 offset:512
    s_waitcnt lgkmcnt(0)
    v_mfma_f32_16x16x32_bf16 v[50:53], v[42:45], v[26:29], 0
    v_mfma_f32_16x16x32_bf16 v[54:57], v[42:45], v[30:33], 0
    v_mfma_f32_16x16x32_bf16 v[58:61], v[42:45], v[34:37], 0
    v_mfma_f32_16x16x32_bf16 v[62:65], v[42:45], v[38:41], 0
    s_nop 7
    s_mov_b64 exec, 0xffff
    ds_write2_b32 v9, v50, v54 offset0:0 offset1:16
    ds_write2_b32 v9, v58, v62 offset0:32 offset1:48
    ds_write2_b32 v9, v51, v55 offset0:64 offset1:80
    ds_write2_b32 v9, v59, v63 offset0:96 offset1:112
    s_mov_b64 exec, -1
    v_mov_b32 v4, 131072
    v_mov_b32 v5, 1
    s_mov_b64 exec, 1
    ds_add_rtn_u32 v5, v4, v5
    s_mov_b64 exec, -1
    s_waitcnt lgkmcnt(0)
    v_readfirstlane_b32 s56, v5
    s_cmp_eq_u32 s56, 7
    s_cbranch_scc0 L_M_done
    ds_read_b64 v[68:69], v16 offset:0
    ds_read_b64 v[70:71], v16 offset:512
    ds_read_b64 v[72:73], v16 offset:1024
    ds_read_b64 v[74:75], v16 offset:1536
    ds_read_b64 v[76:77], v16 offset:2048
    ds_read_b64 v[78:79], v16 offset:2560
    ds_read_b64 v[80:81], v16 offset:3072
    ds_read_b64 v[82:83], v16 offset:3584
    s_waitcnt lgkmcnt(0)
    v_pk_add_f32 v[68:69], v[68:69], v[70:71]
    v_pk_add_f32 v[72:73], v[72:73], v[74:75]
    v_pk_add_f32 v[76:77], v[76:77], v[78:79]
    v_pk_add_f32 v[80:81], v[80:81], v[82:83]
    v_pk_add_f32 v[68:69], v[68:69], v[72:73]
    v_pk_add_f32 v[76:77], v[76:77], v[80:81]
    v_pk_add_f32 v[68:69], v[68:69], v[76:77]
    v_mov_b32 v70, v3
    v_mov_b32 v71, 0
    s_nop 0
    buffer_store_dwordx4 v[68:71], v17, s[8:11], s66 offen sc1

L_M_done:
    v_mov_b32 v4, 131084
    v_mov_b32 v5, 1
    s_mov_b64 exec, 1
    ds_add_u32 v4, v5
    s_mov_b64 exec, -1
    s_branch L_attn
L_role_none:
    s_waitcnt lgkmcnt(0)
    s_load_dword s6, s[40:41], 0
    s_barrier

    s_mov_b32 s8, s40
    s_and_b32 s9, s41, 0xffff
    s_mov_b32 s10, 2097152
    s_mov_b32 s11, 0x20000
    s_waitcnt lgkmcnt(0)
    s_add_u32 s6, s6, 2654435769
    v_mov_b32 v3, s6

L_attn:
    s_lshl_b32 s57, s7, 15
    s_lshl_b32 s58, s4, 12
    s_add_u32 s57, s57, s58
    s_lshl_b32 s58, s3, 9
    s_add_u32 s57, s57, s58
    s_add_u32 s64, s57, 131072
    v_lshrrev_b32 v4, 5, v0
    v_lshlrev_b32 v4, 16, v4
    v_and_b32 v5, 31, v0
    v_lshl_add_u32 v4, v5, 4, v4

    s_mov_b32 s63, 0
L_pl_9:
    buffer_load_dwordx4 v[58:61], v4, s[8:11], s64 offen sc1
    s_add_u32 s63, s63, 1
    s_cmp_gt_u32 s63, 200000
    s_cbranch_scc1 L_plx_10
    s_waitcnt vmcnt(0)
    v_cmp_ne_u32 vcc, v60, v3
    s_cbranch_vccnz L_pl_9
L_plx_10:
    s_waitcnt vmcnt(0)
    v_mov_b32 v62, v58
    v_mov_b32 v63, v59
    s_nop 1
    v_permlane32_swap_b32 v58, v62
    v_permlane32_swap_b32 v59, v63
    v_add_f32 v58, v58, v62
    v_add_f32 v59, v59, v63
    v_cvt_pk_bf16_f32 v58, v58, v59
    s_lshr_b32 s57, s3, 1
    s_mul_i32 s57, s57, 272
    s_and_b32 s58, s3, 1
    s_lshl_b32 s58, s58, 7
    s_add_u32 s57, s57, s58
    s_add_u32 s57, s57, 131584
    v_and_b32 v5, 31, v0
    v_lshlrev_b32 v5, 2, v5
    v_add_u32 v5, s57, v5
    ds_write_b32 v5, v58

    v_mov_b32 v4, 131076
    v_mov_b32 v5, 1
    s_mov_b64 exec, 1
    ds_add_u32 v4, v5
    s_mov_b64 exec, -1
    v_mov_b32 v4, 131088
    s_mov_b32 s63, 0
L_lw_11:
    ds_read_b32 v5, v4
    s_add_u32 s63, s63, 1
    s_cmp_gt_u32 s63, 200000
    s_cbranch_scc1 L_lwx_12
    s_waitcnt lgkmcnt(0)
    v_readfirstlane_b32 s56, v5
    s_cmp_ge_u32 s56, 1
    s_cbranch_scc0 L_lw_11
L_lwx_12:
    s_waitcnt lgkmcnt(0)
    v_xor_b32 v4, v1, v2
    v_lshlrev_b32 v4, 4, v4
    v_lshl_add_u32 v4, v1, 8, v4
    s_lshl_b32 s57, s3, 13
    v_add_u32 v4, s57, v4
    v_xor_b32 v5, 64, v4
    v_xor_b32 v6, 128, v4
    v_xor_b32 v7, 192, v4

    ds_read_b128 v[64:67], v4 offset:0
    ds_read_b128 v[68:71], v5 offset:0
    ds_read_b128 v[72:75], v6 offset:0
    ds_read_b128 v[76:79], v7 offset:0
    ds_read_b128 v[80:83], v4 offset:4096
    ds_read_b128 v[84:87], v5 offset:4096
    ds_read_b128 v[88:91], v6 offset:4096
    ds_read_b128 v[92:95], v7 offset:4096
    v_mov_b32 v4, 131076
    s_mov_b32 s63, 0
L_lw_13:
    ds_read_b32 v5, v4
    s_add_u32 s63, s63, 1
    s_cmp_gt_u32 s63, 200000
    s_cbranch_scc1 L_lwx_14
    s_waitcnt lgkmcnt(0)
    v_readfirstlane_b32 s56, v5
    s_cmp_ge_u32 s56, 8
    s_cbranch_scc0 L_lw_13
L_lwx_14:
    s_waitcnt lgkmcnt(0)
    v_and_b32 v4, 3, v0
    v_mul_u32_u24 v4, 272, v4
    v_lshl_add_u32 v4, v2, 4, v4
    v_add_u32 v4, 131584, v4

    ds_read_b128 v[96:99], v4 offset:0
    ds_read_b128 v[100:103], v4 offset:64
    ds_read_b128 v[104:107], v4 offset:128
    ds_read_b128 v[108:111], v4 offset:192
    s_waitcnt lgkmcnt(0)
    v_mfma_f32_16x16x32_bf16 v[112:115], v[64:67], v[96:99], 0
    v_mfma_f32_16x16x32_bf16 v[116:119], v[80:83], v[96:99], 0
    v_mfma_f32_16x16x32_bf16 v[112:115], v[68:71], v[100:103], v[112:115]
    v_mfma_f32_16x16x32_bf16 v[116:119], v[84:87], v[100:103], v[116:119]
    v_mfma_f32_16x16x32_bf16 v[112:115], v[72:75], v[104:107], v[112:115]
    v_mfma_f32_16x16x32_bf16 v[116:119], v[88:91], v[104:107], v[116:119]
    v_mfma_f32_16x16x32_bf16 v[112:115], v[76:79], v[108:111], v[112:115]
    v_mfma_f32_16x16x32_bf16 v[116:119], v[92:95], v[108:111], v[116:119]
    s_nop 7
    v_cvt_pk_bf16_f32 v58, v112, v113
    v_lshlrev_b32 v112, 16, v58
    v_and_b32 v113, s68, v58
    v_mul_f32 v112, 0x3db504f3, v112
    v_mul_f32 v113, 0x3db504f3, v113
    v_cvt_pk_bf16_f32 v58, v112, v113
    v_lshlrev_b32 v112, 16, v58
    v_and_b32 v113, s68, v58
    v_cvt_pk_bf16_f32 v58, v114, v115
    v_lshlrev_b32 v114, 16, v58
    v_and_b32 v115, s68, v58
    v_mul_f32 v114, 0x3db504f3, v114
    v_mul_f32 v115, 0x3db504f3, v115
    v_cvt_pk_bf16_f32 v58, v114, v115
    v_lshlrev_b32 v114, 16, v58
    v_and_b32 v115, s68, v58
    v_cvt_pk_bf16_f32 v58, v116, v117
    v_lshlrev_b32 v116, 16, v58
    v_and_b32 v117, s68, v58
    v_mul_f32 v116, 0x3db504f3, v116
    v_mul_f32 v117, 0x3db504f3, v117
    v_cvt_pk_bf16_f32 v58, v116, v117
    v_lshlrev_b32 v116, 16, v58
    v_and_b32 v117, s68, v58
    v_cvt_pk_bf16_f32 v58, v118, v119
    v_lshlrev_b32 v118, 16, v58
    v_and_b32 v119, s68, v58
    v_mul_f32 v118, 0x3db504f3, v118
    v_mul_f32 v119, 0x3db504f3, v119
    v_cvt_pk_bf16_f32 v58, v118, v119
    v_lshlrev_b32 v118, 16, v58
    v_and_b32 v119, s68, v58
    v_max3_f32 v58, v112, v113, v114
    v_max3_f32 v58, v58, v115, v116
    v_max3_f32 v58, v58, v117, v118
    v_max_f32 v58, v58, v119

    v_and_b32 v6, 3, v0
    v_lshlrev_b32 v6, 2, v6
    v_add_u32 v6, 131136, v6

    v_mov_b32 v59, v58
    s_nop 1
    v_permlane16_swap_b32 v58, v59
    v_max_f32 v58, v58, v59
    v_mov_b32 v59, v58
    s_nop 1
    v_permlane32_swap_b32 v58, v59
    v_max_f32 v58, v58, v59
    s_mov_b64 exec, 0xf
    ds_max_f32 v6, v58
    s_mov_b64 exec, -1

    v_mov_b32 v4, 131080
    v_mov_b32 v5, 1
    s_mov_b64 exec, 1
    ds_add_u32 v4, v5
    s_mov_b64 exec, -1
    s_lshl_b32 s57, s3, 10
    s_add_u32 s57, s57, 143360
    v_mov_b32 v7, s57
    v_lshl_add_u32 v7, v0, 4, v7
    s_lshl_b32 s57, s3, 4
    s_add_u32 s57, s57, 131328
    v_mov_b32 v8, s57
    v_lshl_add_u32 v8, v0, 2, v8

    v_mov_b32 v4, 131080
    s_mov_b32 s63, 0
L_lw_15:
    ds_read_b32 v5, v4
    s_add_u32 s63, s63, 1
    s_cmp_gt_u32 s63, 200000
    s_cbranch_scc1 L_lwx_16
    s_waitcnt lgkmcnt(0)
    v_readfirstlane_b32 s56, v5
    s_cmp_ge_u32 s56, 8
    s_cbranch_scc0 L_lw_15
L_lwx_16:
    s_waitcnt lgkmcnt(0)
    ds_read_b32 v60, v6
    s_waitcnt lgkmcnt(0)

    v_sub_f32 v112, v112, v60
    v_sub_f32 v113, v113, v60
    v_sub_f32 v114, v114, v60
    v_sub_f32 v115, v115, v60
    v_sub_f32 v116, v116, v60
    v_sub_f32 v117, v117, v60
    v_sub_f32 v118, v118, v60
    v_sub_f32 v119, v119, v60
    v_mul_f32 v112, 0x3fb8aa3b, v112
    v_mul_f32 v113, 0x3fb8aa3b, v113
    v_mul_f32 v114, 0x3fb8aa3b, v114
    v_mul_f32 v115, 0x3fb8aa3b, v115
    v_mul_f32 v116, 0x3fb8aa3b, v116
    v_mul_f32 v117, 0x3fb8aa3b, v117
    v_mul_f32 v118, 0x3fb8aa3b, v118
    v_mul_f32 v119, 0x3fb8aa3b, v119
    v_exp_f32 v112, v112
    v_exp_f32 v113, v113
    v_exp_f32 v114, v114
    v_exp_f32 v115, v115
    v_exp_f32 v116, v116
    v_exp_f32 v117, v117
    v_exp_f32 v118, v118
    v_exp_f32 v119, v119
    s_nop 0
    v_cvt_pk_bf16_f32 v96, v112, v113
    v_cvt_pk_bf16_f32 v97, v114, v115
    v_cvt_pk_bf16_f32 v98, v116, v117
    v_cvt_pk_bf16_f32 v99, v118, v119
    ds_write_b128 v7, v[96:99]
    v_add_f32 v59, v112, v113
    v_add_f32 v61, v114, v115
    v_add_f32 v62, v116, v117
    v_add_f32 v63, v118, v119
    v_add_f32 v59, v59, v61
    v_add_f32 v62, v62, v63
    v_add_f32 v59, v59, v62

    v_mov_b32 v61, v59
    s_nop 1
    v_permlane16_swap_b32 v59, v61
    v_add_f32 v59, v59, v61
    v_mov_b32 v61, v59
    s_nop 1
    v_permlane32_swap_b32 v59, v61
    v_add_f32 v59, v59, v61
    s_mov_b64 exec, 0xf
    ds_write_b32 v8, v59
    s_mov_b64 exec, -1
    v_mov_b32 v6, 131116
    ds_read_b32 v6, v6

    v_mov_b32 v4, 131096
    v_mov_b32 v5, 1
    s_mov_b64 exec, 1
    ds_add_rtn_u32 v5, v4, v5
    s_mov_b64 exec, -1
    s_waitcnt lgkmcnt(0)
    v_readfirstlane_b32 s56, v5
    s_cmp_eq_u32 s56, 7
    v_readfirstlane_b32 s43, v6
    s_cbranch_scc0 L_nostat
    v_and_b32 v4, 31, v0
    v_lshlrev_b32 v4, 2, v4
    v_add_u32 v4, 131328, v4
    ds_read_b32 v61, v4
    v_mov_b32 v62, 0
    v_mov_b32 v63, v3
    s_lshl_b32 s57, s4, 1
    s_add_u32 s57, s57, s7
    s_lshl_b32 s57, s57, 4
    s_add_u32 s57, s57, s69
    s_lshl_b32 s57, s57, 6
    s_add_u32 s57, s57, 262144
    v_lshlrev_b32 v4, 4, v0
    s_waitcnt lgkmcnt(0)
    v_add_f32_dpp v61, v61, v61 row_ror:4 row_mask:0xf bank_mask:0xf
    s_nop 1
    v_add_f32_dpp v61, v61, v61 row_ror:8 row_mask:0xf bank_mask:0xf

    v_mov_b32 v5, v61
    s_nop 1
    v_permlane16_swap_b32 v61, v5
    v_add_f32 v61, v61, v5
    s_mov_b64 exec, 0xf
    s_cmp_eq_u32 s43, 2
    s_cbranch_scc0 L_ls_17
    buffer_store_dwordx4 v[60:63], v4, s[8:11], s57 offen
L_lb_18:
    s_mov_b64 exec, -1
L_nostat:
    s_mov_b32 s66, -1
    s_cmp_lt_u32 s5, 2
    s_cbranch_scc0 L_noM2prep

    s_mov_b32 s44, s34
    s_and_b32 s45, s35, 0xffff
    s_mov_b32 s46, 2048
    s_mov_b32 s47, 0x20000
    v_and_b32 v4, 1, v0
    v_lshlrev_b32 v4, 10, v4
    v_lshl_add_u32 v7, v2, 4, v4
    s_lshl_b32 s57, s62, 9
    s_lshl_b32 s58, s3, 6
    s_add_u32 s57, s57, s58
    buffer_load_dwordx4 v[120:123], v7, s[44:47], s57 offen
    s_waitcnt vmcnt(0)

    v_lshlrev_b32 v58, 16, v120
    v_and_b32 v59, s68, v120
    v_mul_f32 v60, 0xbfb8aa3b, v58
    v_mul_f32 v61, 0xbfb8aa3b, v59
    v_exp_f32 v60, v60
    v_exp_f32 v61, v61
    s_nop 0
    v_add_f32 v60, 1.0, v60
    v_add_f32 v61, 1.0, v61
    v_rcp_f32 v60, v60
    v_rcp_f32 v61, v61
    s_nop 0
    v_mul_f32 v58, v58, v60
    v_mul_f32 v59, v59, v61
    v_cvt_pk_bf16_f32 v120, v58, v59
    v_lshlrev_b32 v58, 16, v121
    v_and_b32 v59, s68, v121
    v_mul_f32 v60, 0xbfb8aa3b, v58
    v_mul_f32 v61, 0xbfb8aa3b, v59
    v_exp_f32 v60, v60
    v_exp_f32 v61, v61
    s_nop 0
    v_add_f32 v60, 1.0, v60
    v_add_f32 v61, 1.0, v61
    v_rcp_f32 v60, v60
    v_rcp_f32 v61, v61
    s_nop 0
    v_mul_f32 v58, v58, v60
    v_mul_f32 v59, v59, v61
    v_cvt_pk_bf16_f32 v121, v58, v59
    v_lshlrev_b32 v58, 16, v122
    v_and_b32 v59, s68, v122
    v_mul_f32 v60, 0xbfb8aa3b, v58
    v_mul_f32 v61, 0xbfb8aa3b, v59
    v_exp_f32 v60, v60
    v_exp_f32 v61, v61
    s_nop 0
    v_add_f32 v60, 1.0, v60
    v_add_f32 v61, 1.0, v61
    v_rcp_f32 v60, v60
    v_rcp_f32 v61, v61
    s_nop 0
    v_mul_f32 v58, v58, v60
    v_mul_f32 v59, v59, v61
    v_cvt_pk_bf16_f32 v122, v58, v59
    v_lshlrev_b32 v58, 16, v123
    v_and_b32 v59, s68, v123
    v_mul_f32 v60, 0xbfb8aa3b, v58
    v_mul_f32 v61, 0xbfb8aa3b, v59
    v_exp_f32 v60, v60
    v_exp_f32 v61, v61
    s_nop 0
    v_add_f32 v60, 1.0, v60
    v_add_f32 v61, 1.0, v61
    v_rcp_f32 v60, v60
    v_rcp_f32 v61, v61
    s_nop 0
    v_mul_f32 v58, v58, v60
    v_mul_f32 v59, v59, v61
    v_cvt_pk_bf16_f32 v123, v58, v59
    s_branch L_nofprep
L_noM2prep:
    s_cmp_lt_u32 s5, 24
    s_cbranch_scc1 L_nofprep

    s_sub_u32 s57, s5, 24
    s_lshl_b32 s58, s4, 3
    s_add_u32 s58, s58, s57
    s_mul_i32 s59, s4, 6
    s_add_u32 s59, s59, s57
    s_add_u32 s59, s59, 8
    s_cmp_lt_u32 s4, 4
    s_cselect_b32 s66, s58, s59
    s_cselect_b32 s58, 8, 6
    s_cmp_lt_u32 s57, s58
    s_cselect_b32 s66, s66, -1

    s_cmp_eq_u32 s66, -1
    s_cbranch_scc1 L_nofprep

    v_lshrrev_b32 v4, 5, v0
    v_mul_u32_u24 v4, 24576, v4
    v_and_b32 v5, 1, v2
    v_mul_u32_u24 v5, 49152, v5
    v_add_u32 v4, v4, v5
    v_lshl_add_u32 v4, v1, 4, v4
    s_lshl_b32 s57, s62, 11
    s_lshl_b32 s58, s3, 8
    s_add_u32 s57, s57, s58
    s_add_u32 s64, s57, 20480
    s_add_u32 s65, s57, 24576

    s_mov_b32 s63, 0
L_pl_19:
    buffer_load_dwordx4 v[96:99], v4, s[8:11], s64 offen sc1
    buffer_load_dwordx4 v[100:103], v4, s[8:11], s65 offen sc1
    s_add_u32 s63, s63, 1
    s_cmp_gt_u32 s63, 200000
    s_cbranch_scc1 L_plx_20
    s_waitcnt vmcnt(0)
    v_xor_b32 v104, v98, v3
    v_bitop3_b32 v104, v104, v102, v3 bitop3:0xf6
    v_cmp_ne_u32 vcc, 0, v104
    s_cbranch_vccnz L_pl_19
L_plx_20:
    s_waitcnt vmcnt(0)
    v_mov_b32 v104, v96
    v_mov_b32 v105, v97
    s_nop 1
    v_permlane16_swap_b32 v96, v104
    v_permlane16_swap_b32 v97, v105
    v_add_f32 v96, v96, v104
    v_add_f32 v97, v97, v105
    v_mov_b32 v104, v100
    v_mov_b32 v105, v101
    s_nop 1
    v_permlane16_swap_b32 v100, v104
    v_permlane16_swap_b32 v101, v105
    v_add_f32 v100, v100, v104
    v_add_f32 v101, v101, v105
    v_mov_b32 v122, v96
    v_mov_b32 v123, v97
    v_cvt_pk_bf16_f32 v104, v122, v123
    v_lshlrev_b32 v122, 16, v104
    v_and_b32 v123, s68, v104
    v_cvt_pk_bf16_f32 v104, v100, v101
    v_lshlrev_b32 v100, 16, v104
    v_and_b32 v101, s68, v104
    v_add_f32 v120, 1.0, v100
    v_add_f32 v121, 1.0, v101
    v_cvt_pk_bf16_f32 v104, v120, v121
    v_lshlrev_b32 v120, 16, v104
    v_and_b32 v121, s68, v104
L_nofprep:
    v_mov_b32 v4, 131096
    s_mov_b32 s63, 0
L_wa_21:
    ds_read_b64 v[58:59], v4
    s_add_u32 s63, s63, 1
    s_cmp_gt_u32 s63, 200000
    s_cbranch_scc1 L_wax_22
    s_waitcnt lgkmcnt(0)
    v_readfirstlane_b32 s56, v58
    v_readfirstlane_b32 s57, v59
    s_cmp_ge_u32 s56, 8
    s_cselect_b32 s56, s57, 0
    s_cmp_ge_u32 s56, 1
    s_cbranch_scc0 L_wa_21
L_wax_22:
    s_waitcnt lgkmcnt(0)

    v_lshlrev_b32 v4, 4, v0
    v_add_u32 v4, 143360, v4

    ds_read_b128 v[64:67], v4 offset:0
    ds_read_b128 v[68:71], v4 offset:1024
    ds_read_b128 v[72:75], v4 offset:2048
    ds_read_b128 v[76:79], v4 offset:3072
    ds_read_b128 v[80:83], v4 offset:4096
    ds_read_b128 v[84:87], v4 offset:5120
    ds_read_b128 v[88:91], v4 offset:6144
    ds_read_b128 v[92:95], v4 offset:7168
    v_lshrrev_b32 v5, 2, v1
    v_lshl_add_u32 v5, v2, 2, v5
    v_and_b32 v6, 7, v5
    v_lshlrev_b32 v6, 1, v6
    v_and_b32 v7, 3, v0
    v_lshrrev_b32 v8, 1, v7
    s_lshl_b32 s57, s3, 1
    v_add_u32 v8, s57, v8
    v_xor_b32 v8, v8, v6
    v_lshlrev_b32 v8, 4, v8
    v_lshl_add_u32 v8, v5, 8, v8
    v_and_b32 v7, 1, v7
    v_lshl_add_u32 v8, v7, 3, v8
    v_add_u32 v8, 65536, v8
    s_lshl_b32 s57, s4, 1
    s_add_u32 s57, s57, s7
    s_lshl_b32 s57, s57, 4
    s_add_u32 s57, s57, s69
    s_lshl_b32 s57, s57, 11
    s_lshl_b32 s58, s3, 8
    s_add_u32 s57, s57, s58
    s_add_u32 s64, s57, 1048576
    v_lshlrev_b32 v7, 4, v1
    s_mov_b32 s58, 0x07060501
    s_mov_b32 s59, 0x07060502
    s_mov_b32 s65, 0x07060503

    ds_read_b64_tr_b16 v[112:113], v8 offset:0
    ds_read_b64_tr_b16 v[114:115], v8 offset:4096
    ds_read_b64_tr_b16 v[116:117], v8 offset:8192
    ds_read_b64_tr_b16 v[118:119], v8 offset:12288
    ds_read_b64_tr_b16 v[124:125], v8 offset:16384
    ds_read_b64_tr_b16 v[126:127], v8 offset:20480
    s_waitcnt lgkmcnt(4)
    v_mfma_f32_16x16x32_bf16 v[42:45], v[64:67], v[112:115], 0
    ds_read_b64_tr_b16 v[112:113], v8 offset:24576
    ds_read_b64_tr_b16 v[114:115], v8 offset:28672
    s_waitcnt lgkmcnt(4)
    v_mfma_f32_16x16x32_bf16 v[42:45], v[68:71], v[116:119], v[42:45]
    ds_read_b64_tr_b16 v[116:117], v8 offset:32768
    ds_read_b64_tr_b16 v[118:119], v8 offset:36864
    s_waitcnt lgkmcnt(4)
    v_mfma_f32_16x16x32_bf16 v[42:45], v[72:75], v[124:127], v[42:45]
    ds_read_b64_tr_b16 v[124:125], v8 offset:40960
    ds_read_b64_tr_b16 v[126:127], v8 offset:45056
    s_waitcnt lgkmcnt(4)
    v_mfma_f32_16x16x32_bf16 v[42:45], v[76:79], v[112:115], v[42:45]
    s_waitcnt lgkmcnt(2)
    v_mfma_f32_16x16x32_bf16 v[42:45], v[80:83], v[116:119], v[42:45]
    s_waitcnt lgkmcnt(0)
    v_mfma_f32_16x16x32_bf16 v[42:45], v[84:87], v[124:127], v[42:45]
    s_barrier
    ds_read_b64_tr_b16 v[112:113], v8 offset:49152
    ds_read_b64_tr_b16 v[114:115], v8 offset:53248
    ds_read_b64_tr_b16 v[116:117], v8 offset:57344
    ds_read_b64_tr_b16 v[118:119], v8 offset:61440
    s_waitcnt lgkmcnt(2)
    v_mfma_f32_16x16x32_bf16 v[42:45], v[88:91], v[112:115], v[42:45]
    s_waitcnt lgkmcnt(0)
    v_mfma_f32_16x16x32_bf16 v[42:45], v[92:95], v[116:119], v[42:45]
    v_mov_b32 v49, v3
    s_nop 6
    v_perm_b32 v46, v42, v45, s58
    v_perm_b32 v47, v43, v45, s59
    v_perm_b32 v48, v44, v45, s65
    s_mov_b64 exec, 0xffff

    s_cmp_eq_u32 s43, 2
    s_cbranch_scc0 L_ls_23
    buffer_store_dwordx4 v[46:49], v7, s[8:11], s64 offen
L_lb_24:
    s_mov_b64 exec, -1
    s_cmp_lt_u32 s5, 2
    s_cbranch_scc1 L_M2_role
    s_cmp_lt_u32 s5, 8
    s_cbranch_scc1 L_cw_end
    s_cmp_lt_u32 s5, 24
    s_cbranch_scc0 L_F_role

    v_and_b32 v8, 1, v0
    v_lshlrev_b32 v8, 11, v8
    v_lshl_add_u32 v8, v2, 5, v8
    s_lshl_b32 s57, s4, 12
    s_lshl_b32 s58, s62, 10
    s_add_u32 s57, s57, s58
    s_lshl_b32 s58, s3, 7
    s_add_u32 s57, s57, s58
    s_add_u32 s64, s57, 278528
    s_lshl_b32 s57, s4, 14
    s_lshl_b32 s58, s62, 13
    s_add_u32 s57, s57, s58
    s_sub_u32 s58, s5, 8
    s_lshr_b32 s58, s58, 1
    s_lshl_b32 s58, s58, 9
    s_add_u32 s57, s57, s58
    s_add_u32 s65, s57, 327680
    v_lshrrev_b32 v17, 5, v0
    v_lshlrev_b32 v17, 12, v17
    v_and_b32 v5, 31, v0
    v_lshl_add_u32 v17, v5, 4, v17

    v_lshrrev_b32 v12, 2, v1
    v_lshrrev_b32 v13, 1, v12
    v_and_b32 v14, 1, v2
    v_lshl_add_u32 v13, v14, 1, v13
    v_lshl_add_u32 v12, v2, 3, v12
    v_lshlrev_b32 v12, 7, v12
    v_lshl_add_u32 v12, v13, 5, v12
    v_and_b32 v13, 3, v0
    v_lshl_add_u32 v12, v13, 3, v12
    s_lshl_b32 s57, s3, 12
    s_add_u32 s57, s57, 0
    v_add_u32 v12, s57, v12
    v_xor_b32 v13, 32, v12
    v_xor_b32 v14, 64, v12
    v_xor_b32 v15, 96, v12
    s_cmp_eq_u32 s3, 1
    s_cbranch_scc0 L_O_noprep

    s_mov_b32 s44, s16
    s_and_b32 s45, s17, 0xffff
    s_mov_b32 s46, 2048
    s_mov_b32 s47, 0x20000
    s_sub_u32 s66, s5, 8
    v_and_b32 v4, 1, v2
    v_lshlrev_b32 v5, 10, v4
    v_lshl_add_u32 v5, v1, 2, v5
    s_lshl_b32 s57, s66, 6
    buffer_load_dword v20, v5, s[44:47], s57 offen
    v_mul_u32_u24 v5, 24576, v4
    v_lshrrev_b32 v6, 5, v0
    v_mul_u32_u24 v6, 49152, v6
    v_add_u32 v5, v5, v6
    v_lshl_add_u32 v5, v1, 4, v5
    s_lshl_b32 s57, s66, 8
    s_add_u32 s67, s57, 16384

    s_mov_b32 s63, 0
L_pl_25:
    buffer_load_dwordx4 v[84:87], v5, s[8:11], s67 offen sc1
    s_add_u32 s63, s63, 1
    s_cmp_gt_u32 s63, 200000
    s_cbranch_scc1 L_plx_26
    s_waitcnt vmcnt(0)
    v_cmp_ne_u32 vcc, v86, v3
    s_cbranch_vccnz L_pl_25
L_plx_26:
    s_waitcnt vmcnt(0)
    v_mov_b32 v88, v84
    v_mov_b32 v89, v85
    s_nop 1
    v_permlane32_swap_b32 v84, v88
    v_permlane32_swap_b32 v85, v89
    v_add_f32 v84, v84, v88
    v_add_f32 v85, v85, v89
    v_cvt_pk_bf16_f32 v88, v84, v85
    v_lshlrev_b32 v84, 16, v88
    v_and_b32 v85, s68, v88
    v_mov_b32 v22, v84
    v_mov_b32 v23, v85

    v_lshlrev_b32 v24, 16, v20
    v_and_b32 v25, s68, v20
L_O_noprep:
    s_sub_u32 s66, s5, 8
    v_lshrrev_b32 v6, 5, v0
    v_lshlrev_b32 v18, 13, v6
    v_and_b32 v4, 1, v2
    v_lshl_add_u32 v18, v4, 12, v18
    v_lshl_add_u32 v18, v1, 4, v18
    v_lshlrev_b32 v19, 7, v4
    v_lshl_add_u32 v19, v1, 3, v19
    v_lshlrev_b32 v21, 4, v4
    s_lshl_b32 s57, s66, 8
    s_add_u32 s48, s57, 327680
    s_lshl_b32 s58, s4, 12
    s_add_u32 s57, s57, s58
    s_add_u32 s49, s57, 458752
    s_lshl_b32 s57, s66, 5
    s_lshl_b32 s58, s4, 9
    s_add_u32 s57, s57, s58
    s_add_u32 s50, s57, 491520

    s_cmp_eq_u32 s3, 1
    s_cbranch_scc0 L_O_nowarm
    s_add_u32 s57, s48, 0
    buffer_load_dwordx4 v[96:99], v18, s[8:11], s57 offen sc1
    s_add_u32 s57, s48, 16384
    buffer_load_dwordx4 v[96:99], v18, s[8:11], s57 offen sc1
    s_add_u32 s57, s48, 32768
    buffer_load_dwordx4 v[96:99], v18, s[8:11], s57 offen sc1
    s_add_u32 s57, s48, 49152
    buffer_load_dwordx4 v[96:99], v18, s[8:11], s57 offen sc1
    s_add_u32 s57, s48, 65536
    buffer_load_dwordx4 v[96:99], v18, s[8:11], s57 offen sc1
    s_add_u32 s57, s48, 81920
    buffer_load_dwordx4 v[96:99], v18, s[8:11], s57 offen sc1
    s_add_u32 s57, s48, 98304
    buffer_load_dwordx4 v[96:99], v18, s[8:11], s57 offen sc1
    s_add_u32 s57, s48, 114688
    buffer_load_dwordx4 v[96:99], v18, s[8:11], s57 offen sc1
L_O_nowarm:
    v_mov_b32 v4, 131108
    s_mov_b32 s63, 0
L_lw_27:
    ds_read_b32 v5, v4
    s_add_u32 s63, s63, 1
    s_cmp_gt_u32 s63, 200000
    s_cbranch_scc1 L_lwx_28
    s_waitcnt lgkmcnt(0)
    v_readfirstlane_b32 s56, v5
    s_cmp_ge_u32 s56, 1
    s_cbranch_scc0 L_lw_27
L_lwx_28:
    s_waitcnt lgkmcnt(0)
    ds_read_b64_tr_b16 v[26:27], v12 offset:0
    ds_read_b64_tr_b16 v[28:29], v12 offset:512
    ds_read_b64_tr_b16 v[30:31], v13 offset:0
    ds_read_b64_tr_b16 v[32:33], v13 offset:512
    ds_read_b64_tr_b16 v[34:35], v14 offset:0
    ds_read_b64_tr_b16 v[36:37], v14 offset:512
    ds_read_b64_tr_b16 v[38:39], v15 offset:0
    ds_read_b64_tr_b16 v[40:41], v15 offset:512
    s_waitcnt lgkmcnt(0)
    s_mov_b32 s63, 0
L_pl_29:
    buffer_load_dwordx4 v[66:69], v8, s[8:11], s64 offen sc1
    buffer_load_dwordx4 v[70:73], v8, s[8:11], s64 offen offset:16 sc1
    s_add_u32 s63, s63, 1
    s_cmp_gt_u32 s63, 200000
    s_cbranch_scc1 L_plx_30
    s_waitcnt vmcnt(0)
    v_xor_b32 v82, v67, v3
    v_bitop3_b32 v82, v82, v69, v3 bitop3:0xf6
    v_bitop3_b32 v82, v82, v71, v3 bitop3:0xf6
    v_bitop3_b32 v82, v82, v73, v3 bitop3:0xf6
    v_cmp_ne_u32 vcc, 0, v82
    s_cbranch_vccnz L_pl_29
L_plx_30:
    s_waitcnt vmcnt(0)
    v_mov_b32 v84, v66
    v_mov_b32 v85, v68
    v_mov_b32 v86, v70
    v_mov_b32 v87, v72

    s_nop 1
    v_mfma_f32_16x16x32_bf16 v[50:53], v[84:87], v[26:29], 0
    v_mfma_f32_16x16x32_bf16 v[54:57], v[84:87], v[30:33], 0
    v_mfma_f32_16x16x32_bf16 v[58:61], v[84:87], v[34:37], 0
    v_mfma_f32_16x16x32_bf16 v[62:65], v[84:87], v[38:41], 0
    s_nop 7
    s_mov_b64 exec, 0xffff
    ds_write2_b32 v9, v50, v54 offset0:0 offset1:16
    ds_write2_b32 v9, v58, v62 offset0:32 offset1:48
    ds_write2_b32 v9, v51, v55 offset0:64 offset1:80
    ds_write2_b32 v9, v59, v63 offset0:96 offset1:112
    s_mov_b64 exec, -1
    s_waitcnt vmcnt(0) lgkmcnt(0)
    s_cmp_eq_u32 s3, 0
    s_barrier
    s_cbranch_scc0 L_O_notw0

    ds_read_b64 v[68:69], v16 offset:0
    ds_read_b64 v[70:71], v16 offset:512
    ds_read_b64 v[72:73], v16 offset:1024
    ds_read_b64 v[74:75], v16 offset:1536
    ds_read_b64 v[76:77], v16 offset:2048
    ds_read_b64 v[78:79], v16 offset:2560
    ds_read_b64 v[80:81], v16 offset:3072
    ds_read_b64 v[82:83], v16 offset:3584
    s_waitcnt lgkmcnt(0)
    v_pk_add_f32 v[68:69], v[68:69], v[70:71]
    v_pk_add_f32 v[72:73], v[72:73], v[74:75]
    v_pk_add_f32 v[76:77], v[76:77], v[78:79]
    v_pk_add_f32 v[80:81], v[80:81], v[82:83]
    v_pk_add_f32 v[68:69], v[68:69], v[72:73]
    v_pk_add_f32 v[76:77], v[76:77], v[80:81]
    v_pk_add_f32 v[68:69], v[68:69], v[76:77]
    v_mov_b32 v70, v3
    v_mov_b32 v71, 0
    s_nop 0
    buffer_store_dwordx4 v[68:71], v17, s[8:11], s65 offen sc1

    s_branch L_cw_end
L_O_notw0:
    s_cmp_eq_u32 s3, 1
    s_cbranch_scc0 L_cw_end
L_X2:
    s_mov_b32 s63, 0
L_pl_31:
    s_add_u32 s57, s48, 0
    buffer_load_dwordx4 v[64:67], v18, s[8:11], s57 offen sc1
    s_add_u32 s57, s48, 16384
    buffer_load_dwordx4 v[68:71], v18, s[8:11], s57 offen sc1
    s_add_u32 s57, s48, 32768
    buffer_load_dwordx4 v[72:75], v18, s[8:11], s57 offen sc1
    s_add_u32 s57, s48, 49152
    buffer_load_dwordx4 v[76:79], v18, s[8:11], s57 offen sc1
    s_add_u32 s57, s48, 65536
    buffer_load_dwordx4 v[80:83], v18, s[8:11], s57 offen sc1
    s_add_u32 s57, s48, 81920
    buffer_load_dwordx4 v[84:87], v18, s[8:11], s57 offen sc1
    s_add_u32 s57, s48, 98304
    buffer_load_dwordx4 v[88:91], v18, s[8:11], s57 offen sc1
    s_add_u32 s57, s48, 114688
    buffer_load_dwordx4 v[92:95], v18, s[8:11], s57 offen sc1
    s_add_u32 s63, s63, 1
    s_cmp_gt_u32 s63, 200000
    s_cbranch_scc1 L_plx_32
    s_waitcnt vmcnt(0)
    v_xor_b32 v136, v66, v3
    v_bitop3_b32 v136, v136, v70, v3 bitop3:0xf6
    v_bitop3_b32 v136, v136, v74, v3 bitop3:0xf6
    v_bitop3_b32 v136, v136, v78, v3 bitop3:0xf6
    v_bitop3_b32 v136, v136, v82, v3 bitop3:0xf6
    v_bitop3_b32 v136, v136, v86, v3 bitop3:0xf6
    v_bitop3_b32 v136, v136, v90, v3 bitop3:0xf6
    v_bitop3_b32 v136, v136, v94, v3 bitop3:0xf6
    v_cmp_ne_u32 vcc, 0, v136
    s_cbranch_vccnz L_pl_31
L_plx_32:
    s_waitcnt vmcnt(0)
    v_pk_add_f32 v[128:129], v[64:65], v[68:69]
    v_pk_add_f32 v[130:131], v[72:73], v[76:77]
    v_pk_add_f32 v[132:133], v[80:81], v[84:85]
    v_pk_add_f32 v[134:135], v[88:89], v[92:93]
    v_pk_add_f32 v[128:129], v[128:129], v[130:131]
    v_pk_add_f32 v[132:133], v[132:133], v[134:135]
    v_pk_add_f32 v[128:129], v[128:129], v[132:133]
    v_mov_b32 v136, v128
    v_mov_b32 v137, v129
    s_nop 1
    v_permlane32_swap_b32 v128, v136
    v_permlane32_swap_b32 v129, v137
    v_add_f32 v128, v128, v136
    v_add_f32 v129, v129, v137
    v_cvt_pk_bf16_f32 v136, v128, v129
    v_lshlrev_b32 v128, 16, v136
    v_and_b32 v129, s68, v136
    v_mul_f32 v128, v128, v22
    v_mul_f32 v129, v129, v23
    v_cvt_pk_bf16_f32 v136, v128, v129
    v_lshlrev_b32 v128, 16, v136
    v_and_b32 v129, s68, v136
    v_add_f32 v128, v128, v24
    v_add_f32 v129, v129, v25
    v_cvt_pk_bf16_f32 v132, v128, v129
    v_mov_b32 v133, v3
    s_mov_b32 exec_hi, 0

    s_cmp_eq_u32 s43, 2
    s_cbranch_scc0 L_ls_33
    buffer_store_dwordx2 v[132:133], v19, s[8:11], s49 offen
L_lb_34:
    s_mov_b64 exec, -1
    v_lshlrev_b32 v134, 16, v132
    v_and_b32 v135, s68, v132
    v_add_f32 v136, v134, v135
    v_mul_f32 v137, v134, v134
    v_fmac_f32 v137, v135, v135
    s_nop 1
    v_add_f32_dpp v136, v136, v136 quad_perm:[1,0,3,2] row_mask:0xf bank_mask:0xf
    v_add_f32_dpp v137, v137, v137 quad_perm:[1,0,3,2] row_mask:0xf bank_mask:0xf
    s_nop 1
    v_add_f32_dpp v136, v136, v136 quad_perm:[2,3,0,1] row_mask:0xf bank_mask:0xf
    v_add_f32_dpp v137, v137, v137 quad_perm:[2,3,0,1] row_mask:0xf bank_mask:0xf
    s_nop 1
    v_add_f32_dpp v136, v136, v136 row_half_mirror row_mask:0xf bank_mask:0xf
    v_add_f32_dpp v137, v137, v137 row_half_mirror row_mask:0xf bank_mask:0xf
    s_nop 1
    v_add_f32_dpp v136, v136, v136 row_ror:8 row_mask:0xf bank_mask:0xf
    v_add_f32_dpp v137, v137, v137 row_ror:8 row_mask:0xf bank_mask:0xf
    v_mov_b32 v138, v3
    v_mov_b32 v139, 0
    s_mov_b64 exec, 0x10001

    s_cmp_eq_u32 s43, 2
    s_cbranch_scc0 L_ls_35
    buffer_store_dwordx4 v[136:139], v21, s[8:11], s50 offen
L_lb_36:
    s_mov_b64 exec, -1
    s_branch L_cw_end
L_M2_role:
    v_lshrrev_b32 v12, 2, v1
    v_lshrrev_b32 v13, 1, v12
    v_and_b32 v14, 1, v2
    v_lshl_add_u32 v13, v14, 1, v13
    v_lshl_add_u32 v12, v2, 3, v12
    v_lshlrev_b32 v12, 7, v12
    v_lshl_add_u32 v12, v13, 5, v12
    v_and_b32 v13, 3, v0
    v_lshl_add_u32 v12, v13, 3, v12
    s_lshl_b32 s57, s3, 12
    s_add_u32 s57, s57, 0
    v_add_u32 v12, s57, v12
    v_xor_b32 v13, 32, v12
    v_xor_b32 v14, 64, v12
    v_xor_b32 v15, 96, v12
    s_lshl_b32 s57, s4, 1
    s_add_u32 s57, s57, s5
    s_add_u32 s57, s57, 80
    s_lshr_b32 s66, s57, 1

    v_lshrrev_b32 v17, 5, v0
    v_mul_u32_u24 v17, 24576, v17
    v_and_b32 v5, 31, v0
    v_lshl_add_u32 v17, v5, 4, v17
    s_lshl_b32 s57, s66, 9
    s_mul_i32 s58, s62, 49152
    s_add_u32 s57, s57, s58
    s_add_u32 s66, s57, 8192

    v_mov_b32 v4, 131108
    s_mov_b32 s63, 0
L_lw_37:
    ds_read_b32 v5, v4
    s_add_u32 s63, s63, 1
    s_cmp_gt_u32 s63, 200000
    s_cbranch_scc1 L_lwx_38
    s_waitcnt lgkmcnt(0)
    v_readfirstlane_b32 s56, v5
    s_cmp_ge_u32 s56, 1
    s_cbranch_scc0 L_lw_37
L_lwx_38:
    s_waitcnt lgkmcnt(0)
    ds_read_b64_tr_b16 v[26:27], v12 offset:0
    ds_read_b64_tr_b16 v[28:29], v12 offset:512
    ds_read_b64_tr_b16 v[30:31], v13 offset:0
    ds_read_b64_tr_b16 v[32:33], v13 offset:512
    ds_read_b64_tr_b16 v[34:35], v14 offset:0
    ds_read_b64_tr_b16 v[36:37], v14 offset:512
    ds_read_b64_tr_b16 v[38:39], v15 offset:0
    ds_read_b64_tr_b16 v[40:41], v15 offset:512
    s_waitcnt lgkmcnt(0)
    v_mfma_f32_16x16x32_bf16 v[50:53], v[120:123], v[26:29], 0
    v_mfma_f32_16x16x32_bf16 v[54:57], v[120:123], v[30:33], 0
    v_mfma_f32_16x16x32_bf16 v[58:61], v[120:123], v[34:37], 0
    v_mfma_f32_16x16x32_bf16 v[62:65], v[120:123], v[38:41], 0
    s_nop 7
    s_mov_b64 exec, 0xffff
    ds_write2_b32 v9, v50, v54 offset0:0 offset1:16
    ds_write2_b32 v9, v58, v62 offset0:32 offset1:48
    ds_write2_b32 v9, v51, v55 offset0:64 offset1:80
    ds_write2_b32 v9, v59, v63 offset0:96 offset1:112
    s_mov_b64 exec, -1
    v_mov_b32 v4, 131128
    v_mov_b32 v5, 1
    s_mov_b64 exec, 1
    ds_add_rtn_u32 v5, v4, v5
    s_mov_b64 exec, -1
    s_waitcnt lgkmcnt(0)
    v_readfirstlane_b32 s56, v5
    s_cmp_eq_u32 s56, 7
    s_cbranch_scc0 L_cw_end
    ds_read_b64 v[68:69], v16 offset:0
    ds_read_b64 v[70:71], v16 offset:512
    ds_read_b64 v[72:73], v16 offset:1024
    ds_read_b64 v[74:75], v16 offset:1536
    ds_read_b64 v[76:77], v16 offset:2048
    ds_read_b64 v[78:79], v16 offset:2560
    ds_read_b64 v[80:81], v16 offset:3072
    ds_read_b64 v[82:83], v16 offset:3584
    s_waitcnt lgkmcnt(0)
    v_pk_add_f32 v[68:69], v[68:69], v[70:71]
    v_pk_add_f32 v[72:73], v[72:73], v[74:75]
    v_pk_add_f32 v[76:77], v[76:77], v[78:79]
    v_pk_add_f32 v[80:81], v[80:81], v[82:83]
    v_pk_add_f32 v[68:69], v[68:69], v[72:73]
    v_pk_add_f32 v[76:77], v[76:77], v[80:81]
    v_pk_add_f32 v[68:69], v[68:69], v[76:77]
    v_mov_b32 v70, v3
    v_mov_b32 v71, 0
    s_nop 0
    buffer_store_dwordx4 v[68:71], v17, s[8:11], s66 offen sc1

    s_branch L_cw_end
L_F_role:
    s_cmp_eq_u32 s66, -1
    s_cbranch_scc1 L_cw_end

    s_lshl_b32 s57, s66, 10
    s_add_u32 s57, s57, 499712
    v_lshlrev_b32 v8, 4, v0
    buffer_load_dwordx4 v[84:87], v8, s[8:11], s57 offen sc1

    v_lshrrev_b32 v12, 2, v1
    v_lshrrev_b32 v13, 1, v12
    v_and_b32 v14, 1, v2
    v_lshl_add_u32 v13, v14, 1, v13
    v_lshl_add_u32 v12, v2, 3, v12
    v_lshlrev_b32 v12, 7, v12
    v_lshl_add_u32 v12, v13, 5, v12
    v_and_b32 v13, 3, v0
    v_lshl_add_u32 v12, v13, 3, v12
    s_lshl_b32 s57, s3, 12
    s_add_u32 s57, s57, 0
    v_add_u32 v12, s57, v12
    v_xor_b32 v13, 32, v12
    v_xor_b32 v14, 64, v12
    v_xor_b32 v15, 96, v12
    v_mov_b32 v4, 131108
    s_mov_b32 s63, 0
L_lw_39:
    ds_read_b32 v5, v4
    s_add_u32 s63, s63, 1
    s_cmp_gt_u32 s63, 200000
    s_cbranch_scc1 L_lwx_40
    s_waitcnt lgkmcnt(0)
    v_readfirstlane_b32 s56, v5
    s_cmp_ge_u32 s56, 1
    s_cbranch_scc0 L_lw_39
L_lwx_40:
    s_waitcnt lgkmcnt(0)
    ds_read_b64_tr_b16 v[26:27], v12 offset:0
    ds_read_b64_tr_b16 v[28:29], v12 offset:512
    ds_read_b64_tr_b16 v[30:31], v13 offset:0
    ds_read_b64_tr_b16 v[32:33], v13 offset:512
    ds_read_b64_tr_b16 v[34:35], v14 offset:0
    ds_read_b64_tr_b16 v[36:37], v14 offset:512
    ds_read_b64_tr_b16 v[38:39], v15 offset:0
    ds_read_b64_tr_b16 v[40:41], v15 offset:512
    ds_read_b64_tr_b16 v[128:129], v12 offset:32768
    ds_read_b64_tr_b16 v[130:131], v12 offset:33280
    ds_read_b64_tr_b16 v[132:133], v13 offset:32768
    ds_read_b64_tr_b16 v[134:135], v13 offset:33280
    ds_read_b64_tr_b16 v[136:137], v14 offset:32768
    ds_read_b64_tr_b16 v[138:139], v14 offset:33280
    ds_read_b64_tr_b16 v[140:141], v15 offset:32768
    ds_read_b64_tr_b16 v[142:143], v15 offset:33280
    v_mov_b32 v4, 131112
    s_mov_b32 s63, 0
L_lw_41:
    ds_read_b32 v5, v4
    s_add_u32 s63, s63, 1
    s_cmp_gt_u32 s63, 200000
    s_cbranch_scc1 L_lwx_42
    s_waitcnt lgkmcnt(0)
    v_readfirstlane_b32 s56, v5
    s_cmp_ge_u32 s56, 1
    s_cbranch_scc0 L_lw_41
L_lwx_42:
    s_waitcnt lgkmcnt(0)
    v_lshrrev_b32 v4, 2, v1
    v_and_b32 v5, 1, v2
    v_lshl_add_u32 v5, v5, 2, v4
    v_lshlrev_b32 v5, 1, v5
    v_and_b32 v6, 3, v0
    v_lshrrev_b32 v7, 1, v6
    s_lshl_b32 s57, s3, 3
    v_add_u32 v7, s57, v7
    v_xor_b32 v7, v7, v5
    v_lshlrev_b32 v7, 4, v7
    v_and_b32 v6, 1, v6
    v_lshl_add_u32 v7, v6, 3, v7
    v_lshl_add_u32 v4, v2, 3, v4
    v_lshl_add_u32 v7, v4, 10, v7
    v_add_u32 v7, 65536, v7

    ds_read_b64_tr_b16 v[96:97], v7 offset:0
    ds_read_b64_tr_b16 v[98:99], v7 offset:4096
    v_xor_b32 v6, 32, v7
    ds_read_b64_tr_b16 v[100:101], v6 offset:0
    ds_read_b64_tr_b16 v[102:103], v6 offset:4096
    v_xor_b32 v6, 64, v7
    ds_read_b64_tr_b16 v[104:105], v6 offset:0
    ds_read_b64_tr_b16 v[106:107], v6 offset:4096
    v_xor_b32 v6, 96, v7
    ds_read_b64_tr_b16 v[108:109], v6 offset:0
    ds_read_b64_tr_b16 v[110:111], v6 offset:4096
    v_lshrrev_b32 v6, 5, v0
    v_lshlrev_b32 v20, 7, v6
    v_lshl_add_u32 v20, v1, 3, v20
    s_lshl_b32 s57, s4, 12
    s_lshl_b32 s58, s62, 11
    s_add_u32 s57, s57, s58
    s_lshl_b32 s58, s3, 8
    s_add_u32 s57, s57, s58
    s_add_u32 s64, s57, 458752
    v_lshlrev_b32 v21, 5, v1
    v_lshl_add_u32 v21, v6, 4, v21
    s_lshl_b32 s57, s4, 9
    s_add_u32 s65, s57, 491520
    v_lshlrev_b32 v4, 12, v6
    v_and_b32 v5, 1, v2
    v_lshl_add_u32 v4, v5, 8, v4
    v_lshl_add_u32 v4, v1, 3, v4
    v_add_u32 v4, 135168, v4
    s_lshl_b32 s57, s62, 7
    v_xor_b32 v19, 128, v4
    v_add_u32 v18, s57, v4
    v_subrev_u32 v19, s57, v19
    v_add_u32 v22, 4096, v9
    s_xor_b32 s57, s66, 1
    s_lshl_b32 s57, s57, 10
    s_add_u32 s48, s57, 499712
    s_lshl_b32 s57, s66, 10
    s_add_u32 s49, s57, 499712
    v_lshlrev_b32 v8, 4, v0
    s_lshl_b32 s57, s3, 8
    s_add_u32 s57, s57, 133120
    v_and_b32 v23, 31, v0
    v_lshlrev_b32 v23, 2, v23
    v_add_u32 v23, s57, v23
    s_lshl_b32 s57, s66, 13
    s_lshl_b32 s58, s3, 10
    s_add_u32 s57, s57, s58
    s_add_u32 s50, s57, 589824
    v_lshlrev_b32 v24, 4, v1
    v_mov_b32 v25, 0xbdd2d3e8
    s_waitcnt lgkmcnt(0)

    s_mov_b32 s63, 0
L_pl_43:
    buffer_load_dwordx2 v[112:113], v20, s[8:11], s64 offen sc1
    buffer_load_dwordx4 v[114:117], v21, s[8:11], s65 offen sc1
    s_add_u32 s63, s63, 1
    s_cmp_gt_u32 s63, 200000
    s_cbranch_scc1 L_plx_44
    s_waitcnt vmcnt(0)
    v_xor_b32 v56, v113, v3
    v_bitop3_b32 v56, v56, v116, v3 bitop3:0xf6
    v_cmp_ne_u32 vcc, 0, v56
    s_cbranch_vccnz L_pl_43
L_plx_44:
    s_waitcnt vmcnt(0)
    v_mov_b32 v84, v114
    v_mov_b32 v85, v115
    v_mov_b32 v82, v112

    s_nop 1
    v_add_f32_dpp v84, v84, v84 quad_perm:[1,0,3,2] row_mask:0xf bank_mask:0xf
    v_add_f32_dpp v85, v85, v85 quad_perm:[1,0,3,2] row_mask:0xf bank_mask:0xf
    s_nop 1
    v_add_f32_dpp v84, v84, v84 quad_perm:[2,3,0,1] row_mask:0xf bank_mask:0xf
    v_add_f32_dpp v85, v85, v85 quad_perm:[2,3,0,1] row_mask:0xf bank_mask:0xf
    s_nop 1
    v_add_f32_dpp v84, v84, v84 row_half_mirror row_mask:0xf bank_mask:0xf
    v_add_f32_dpp v85, v85, v85 row_half_mirror row_mask:0xf bank_mask:0xf
    s_nop 1
    v_add_f32_dpp v84, v84, v84 row_ror:8 row_mask:0xf bank_mask:0xf
    v_add_f32_dpp v85, v85, v85 row_ror:8 row_mask:0xf bank_mask:0xf
    v_mul_f32 v84, 0x3b000000, v84
    v_mul_f32 v85, 0x3b000000, v85
    v_fma_f32 v85, -v84, v84, v85
    v_max_f32 v85, 0, v85
    v_cvt_pk_bf16_f32 v79, v84, v85
    v_lshlrev_b32 v76, 16, v79
    v_and_b32 v77, s68, v79
    v_add_f32 v77, 0x3727c5ac, v77
    v_cvt_pk_bf16_f32 v79, v77, v77
    v_lshlrev_b32 v77, 16, v79
    v_sqrt_f32 v77, v77
    s_nop 0
    v_cvt_pk_bf16_f32 v79, v77, v77
    v_lshlrev_b32 v77, 16, v79
    v_rcp_f32 v78, v77
    s_nop 0
    v_lshlrev_b32 v50, 16, v82
    v_and_b32 v51, s68, v82
    v_sub_f32 v50, v50, v76
    v_sub_f32 v51, v51, v76
    v_cvt_pk_bf16_f32 v56, v50, v51
    v_lshlrev_b32 v50, 16, v56
    v_and_b32 v51, s68, v56
    v_mul_f32 v52, v50, v78
    v_mul_f32 v53, v51, v78
    v_fma_f32 v54, -v52, v77, v50
    v_fma_f32 v55, -v53, v77, v51
    v_fma_f32 v50, v54, v78, v52
    v_fma_f32 v51, v55, v78, v53
    v_cvt_pk_bf16_f32 v56, v50, v51
    v_lshlrev_b32 v50, 16, v56
    v_and_b32 v51, s68, v56
    v_mul_f32 v50, v50, v120
    v_mul_f32 v51, v51, v121
    v_cvt_pk_bf16_f32 v56, v50, v51
    v_lshlrev_b32 v50, 16, v56
    v_and_b32 v51, s68, v56
    v_add_f32 v50, v50, v122
    v_add_f32 v51, v51, v123
    v_cvt_pk_bf16_f32 v79, v50, v51
    ds_write_b32 v10, v79
    ds_read_b128 v[42:45], v11
    s_waitcnt lgkmcnt(0)

    v_mfma_f32_16x16x32_bf16 v[50:53], v[42:45], v[26:29], 0
    v_mfma_f32_16x16x32_bf16 v[54:57], v[42:45], v[30:33], 0
    v_mfma_f32_16x16x32_bf16 v[58:61], v[42:45], v[34:37], 0
    v_mfma_f32_16x16x32_bf16 v[62:65], v[42:45], v[38:41], 0
    v_mfma_f32_16x16x32_bf16 v[66:69], v[42:45], v[128:131], 0
    v_mfma_f32_16x16x32_bf16 v[70:73], v[42:45], v[132:135], 0
    v_mfma_f32_16x16x32_bf16 v[74:77], v[42:45], v[136:139], 0
    v_mfma_f32_16x16x32_bf16 v[78:81], v[42:45], v[140:143], 0
    s_nop 3
    s_mov_b64 exec, 0xffff
    ds_write2_b32 v9, v50, v54 offset0:0 offset1:16
    ds_write2_b32 v9, v58, v62 offset0:32 offset1:48
    ds_write2_b32 v9, v51, v55 offset0:64 offset1:80
    ds_write2_b32 v9, v59, v63 offset0:96 offset1:112
    ds_write2_b32 v22, v66, v70 offset0:0 offset1:16
    ds_write2_b32 v22, v74, v78 offset0:32 offset1:48
    ds_write2_b32 v22, v67, v71 offset0:64 offset1:80
    ds_write2_b32 v22, v75, v79 offset0:96 offset1:112
    s_mov_b64 exec, -1
    s_waitcnt lgkmcnt(0)
    s_barrier
    s_cmp_eq_u32 s3, 7
    s_cbranch_scc0 L_F_nox

    ds_read_b64 v[50:51], v19 offset:0
    ds_read_b64 v[52:53], v19 offset:512
    ds_read_b64 v[54:55], v19 offset:1024
    ds_read_b64 v[56:57], v19 offset:1536
    ds_read_b64 v[58:59], v19 offset:2048
    ds_read_b64 v[60:61], v19 offset:2560
    ds_read_b64 v[62:63], v19 offset:3072
    ds_read_b64 v[64:65], v19 offset:3584
    s_waitcnt lgkmcnt(0)
    v_pk_add_f32 v[50:51], v[50:51], v[52:53]
    v_pk_add_f32 v[54:55], v[54:55], v[56:57]
    v_pk_add_f32 v[58:59], v[58:59], v[60:61]
    v_pk_add_f32 v[62:63], v[62:63], v[64:65]
    v_pk_add_f32 v[50:51], v[50:51], v[54:55]
    v_pk_add_f32 v[58:59], v[58:59], v[62:63]
    v_pk_add_f32 v[50:51], v[50:51], v[58:59]
    v_mov_b32 v52, v3
    v_mov_b32 v53, 0

    s_cmp_eq_u32 s43, 2
    s_cbranch_scc0 L_ls_45
    buffer_store_dwordx4 v[50:53], v8, s[8:11], s48 offen
L_lb_46:
L_F_nox:
    ds_read_b64 v[68:69], v18 offset:0
    ds_read_b64 v[70:71], v18 offset:512
    ds_read_b64 v[72:73], v18 offset:1024
    ds_read_b64 v[74:75], v18 offset:1536
    ds_read_b64 v[76:77], v18 offset:2048
    ds_read_b64 v[78:79], v18 offset:2560
    ds_read_b64 v[80:81], v18 offset:3072
    ds_read_b64 v[82:83], v18 offset:3584
    s_waitcnt lgkmcnt(0)
    v_pk_add_f32 v[68:69], v[68:69], v[70:71]
    v_pk_add_f32 v[72:73], v[72:73], v[74:75]
    v_pk_add_f32 v[76:77], v[76:77], v[78:79]
    v_pk_add_f32 v[80:81], v[80:81], v[82:83]
    v_pk_add_f32 v[68:69], v[68:69], v[72:73]
    v_pk_add_f32 v[76:77], v[76:77], v[80:81]
    v_pk_add_f32 v[68:69], v[68:69], v[76:77]
    s_mov_b32 s63, 0
L_pl_47:
    buffer_load_dwordx4 v[84:87], v8, s[8:11], s49 offen sc1
    s_add_u32 s63, s63, 1
    s_cmp_gt_u32 s63, 200000
    s_cbranch_scc1 L_plx_48
    s_waitcnt vmcnt(0)
    v_cmp_ne_u32 vcc, v86, v3
    s_cbranch_vccnz L_pl_47
L_plx_48:
    s_waitcnt vmcnt(0)
    v_add_f32 v68, v68, v84
    v_add_f32 v69, v69, v85
    v_cvt_pk_bf16_f32 v70, v68, v69
    v_mov_b32 v71, v70
    s_nop 1
    v_permlane32_swap_b32 v70, v71

    v_lshlrev_b32 v72, 16, v70
    v_and_b32 v73, s68, v70
    v_lshlrev_b32 v74, 16, v71
    v_and_b32 v75, s68, v71
    v_mul_f32 v76, v72, v72
    v_mul_f32 v77, v73, v73
    v_fmaak_f32 v76, v76, v25, 0xc0135761
    v_fmaak_f32 v77, v77, v25, 0xc0135761
    v_mul_f32 v76, v76, v72
    v_mul_f32 v77, v77, v73
    v_exp_f32 v76, v76
    v_exp_f32 v77, v77
    s_nop 0
    v_add_f32 v76, 1.0, v76
    v_add_f32 v77, 1.0, v77
    v_rcp_f32 v76, v76
    v_rcp_f32 v77, v77
    s_nop 0
    v_mul_f32 v72, v72, v76
    v_mul_f32 v73, v73, v77
    v_cvt_pk_bf16_f32 v76, v72, v73
    v_lshlrev_b32 v72, 16, v76
    v_and_b32 v73, s68, v76
    v_mul_f32 v72, v72, v74
    v_mul_f32 v73, v73, v75
    v_cvt_pk_bf16_f32 v72, v72, v73
    ds_write_b32 v23, v72
    ds_read_b128 v[42:45], v11
    s_waitcnt lgkmcnt(0)

    v_mfma_f32_16x16x32_bf16 v[60:63], v[42:45], v[96:99], 0
    v_mfma_f32_16x16x32_bf16 v[64:67], v[42:45], v[100:103], 0
    v_mfma_f32_16x16x32_bf16 v[68:71], v[42:45], v[104:107], 0
    v_mfma_f32_16x16x32_bf16 v[72:75], v[42:45], v[108:111], 0
    s_nop 3
    s_mov_b64 exec, 0xffff
    v_mov_b32 v63, v3
    buffer_store_dwordx4 v[60:63], v24, s[8:11], s50 offen offset:0 sc1
    v_mov_b32 v67, v3
    buffer_store_dwordx4 v[64:67], v24, s[8:11], s50 offen offset:256 sc1
    v_mov_b32 v71, v3
    buffer_store_dwordx4 v[68:71], v24, s[8:11], s50 offen offset:512 sc1
    v_mov_b32 v75, v3
    buffer_store_dwordx4 v[72:75], v24, s[8:11], s50 offen offset:768 sc1
    s_mov_b64 exec, -1
L_cw_end:
    s_endpgm
L_aux:
    s_waitcnt lgkmcnt(0)
    s_barrier
    s_load_dword s6, s[40:41], 0

    s_mov_b32 s8, s40
    s_and_b32 s9, s41, 0xffff
    s_mov_b32 s10, 2097152
    s_mov_b32 s11, 0x20000
    s_waitcnt lgkmcnt(0)
    s_add_u32 s6, s6, 2654435769
    v_mov_b32 v3, s6
    s_getreg_b32 s57, hwreg(HW_REG_XCC_ID)
    s_and_b32 s57, s57, 0xf
    v_mov_b32 v10, s57
    v_mov_b32 v11, v3
    s_lshl_b32 s58, s4, 8
    s_add_u32 s64, s58, 4096
    s_lshl_b32 s59, s5, 3
    v_mov_b32 v4, s59
    s_mov_b64 exec, 1
    buffer_store_dwordx2 v[10:11], v4, s[8:11], s64 offen sc1
    s_mov_b64 exec, -1
    s_cmp_lt_u32 s99, 2
    s_cselect_b32 s65, 4, 0
    s_add_u32 s65, s65, 131088

    v_mov_b32 v4, s65
    s_mov_b32 s63, 0
L_lw_57:
    ds_read_b32 v5, v4
    s_add_u32 s63, s63, 1
    s_cmp_gt_u32 s63, 200000
    s_cbranch_scc1 L_lwx_58
    s_waitcnt lgkmcnt(0)
    v_readfirstlane_b32 s56, v5
    s_cmp_ge_u32 s56, 1
    s_cbranch_scc0 L_lw_57
L_lwx_58:
    s_waitcnt lgkmcnt(0)
    v_and_b32 v4, 31, v0
    v_lshlrev_b32 v4, 3, v4

    s_mov_b32 s63, 0
L_pl_59:
    buffer_load_dwordx2 v[12:13], v4, s[8:11], s64 offen sc1
    s_add_u32 s63, s63, 1
    s_cmp_gt_u32 s63, 200000
    s_cbranch_scc1 L_plx_60
    s_waitcnt vmcnt(0)
    v_cmp_ne_u32 vcc, v13, v3
    s_cbranch_vccnz L_pl_59
L_plx_60:
    s_waitcnt vmcnt(0)
    v_cmp_ne_u32 vcc, v12, v10
    v_xor_b32 v14, v13, v3
    v_cmp_ne_u32 s[56:57], 0, v14
    s_or_b64 vcc, vcc, s[56:57]
    s_cmp_eq_u64 vcc, 0
    s_cselect_b32 s43, 2, 1
    v_mov_b32 v4, 131116
    v_mov_b32 v5, s43
    s_mov_b64 exec, 1
    ds_write_b32 v4, v5
    s_mov_b64 exec, -1
    s_cmp_lt_u32 s5, 8
    s_cbranch_scc0 L_exit

    v_mov_b32 v4, 131088
    s_mov_b32 s63, 0
L_lw_61:
    ds_read_b32 v5, v4
    s_add_u32 s63, s63, 1
    s_cmp_gt_u32 s63, 200000
    s_cbranch_scc1 L_lwx_62
    s_waitcnt lgkmcnt(0)
    v_readfirstlane_b32 s56, v5
    s_cmp_ge_u32 s56, 1
    s_cbranch_scc0 L_lw_61
L_lwx_62:
    s_waitcnt lgkmcnt(0)
    s_lshl_b32 s57, s4, 1
    s_add_u32 s57, s57, s7
    s_lshl_b32 s57, s57, 15
    s_lshr_b32 s58, s5, 1
    s_lshl_b32 s58, s58, 9
    s_add_u32 s57, s57, s58
    s_add_u32 s64, s57, 1048576
    v_lshrrev_b32 v4, 5, v0
    v_lshlrev_b32 v4, 11, v4
    v_and_b32 v5, 31, v0
    v_lshl_add_u32 v4, v5, 4, v4

    s_add_u32 s54, s64, 0
    buffer_load_dwordx4 v[80:83], v4, s[8:11], s54 offen sc1
    s_add_u32 s54, s64, 4096
    buffer_load_dwordx4 v[80:83], v4, s[8:11], s54 offen sc1
    s_add_u32 s54, s64, 8192
    buffer_load_dwordx4 v[80:83], v4, s[8:11], s54 offen sc1
    s_add_u32 s54, s64, 12288
    buffer_load_dwordx4 v[80:83], v4, s[8:11], s54 offen sc1
    s_add_u32 s54, s64, 16384
    buffer_load_dwordx4 v[80:83], v4, s[8:11], s54 offen sc1
    s_add_u32 s54, s64, 20480
    buffer_load_dwordx4 v[80:83], v4, s[8:11], s54 offen sc1
    s_add_u32 s54, s64, 24576
    buffer_load_dwordx4 v[80:83], v4, s[8:11], s54 offen sc1
    s_add_u32 s54, s64, 28672
    buffer_load_dwordx4 v[80:83], v4, s[8:11], s54 offen sc1
    s_lshl_b32 s57, s4, 1
    s_add_u32 s57, s57, s7
    s_lshl_b32 s57, s57, 10
    s_add_u32 s64, s57, 262144
    v_lshlrev_b32 v4, 4, v0

    v_mov_b32 v5, 131096
    s_mov_b32 s63, 0
L_lw_63:
    ds_read_b32 v6, v5
    s_add_u32 s63, s63, 1
    s_cmp_gt_u32 s63, 200000
    s_cbranch_scc1 L_lwx_64
    s_waitcnt lgkmcnt(0)
    v_readfirstlane_b32 s56, v6
    s_cmp_ge_u32 s56, 8
    s_cbranch_scc0 L_lw_63
L_lwx_64:
    s_waitcnt lgkmcnt(0)
    s_mov_b32 s63, 0
L_pl_65:
    buffer_load_dwordx4 v[16:19], v4, s[8:11], s64 offen sc1
    s_add_u32 s63, s63, 1
    s_cmp_gt_u32 s63, 200000
    s_cbranch_scc1 L_plx_66
    s_waitcnt vmcnt(0)
    v_cmp_ne_u32 vcc, v19, v3
    s_cbranch_vccnz L_pl_65
L_plx_66:
    s_waitcnt vmcnt(0)
    v_mov_b32 v20, v16
    s_nop 1
    v_max_f32_dpp v20, v20, v20 row_ror:4 row_mask:0xf bank_mask:0xf
    s_nop 1
    v_max_f32_dpp v20, v20, v20 row_ror:8 row_mask:0xf bank_mask:0xf
    v_mov_b32 v21, v20
    s_nop 1
    v_permlane16_swap_b32 v20, v21
    v_max_f32 v20, v20, v21
    v_mov_b32 v21, v20
    s_nop 1
    v_permlane32_swap_b32 v20, v21
    v_max_f32 v20, v20, v21
    v_sub_f32 v22, v16, v20
    v_mul_f32 v22, 0x3fb8aa3b, v22
    v_exp_f32 v22, v22
    s_nop 0
    v_mul_f32 v23, v22, v17
    s_nop 1
    v_add_f32_dpp v23, v23, v23 row_ror:4 row_mask:0xf bank_mask:0xf
    s_nop 1
    v_add_f32_dpp v23, v23, v23 row_ror:8 row_mask:0xf bank_mask:0xf
    v_mov_b32 v21, v23
    s_nop 1
    v_permlane16_swap_b32 v23, v21
    v_add_f32 v23, v23, v21
    v_mov_b32 v21, v23
    s_nop 1
    v_permlane32_swap_b32 v23, v21
    v_add_f32 v23, v23, v21
    v_rcp_f32 v24, v23
    s_nop 0
    v_fma_f32 v25, -v23, v24, 1.0
    v_fma_f32 v24, v25, v24, v24
    v_mul_f32 v22, v22, v24
    v_lshlrev_b32 v4, 2, v0
    v_add_u32 v4, 151552, v4
    ds_write_b32 v4, v22
    v_lshrrev_b32 v5, 5, v0
    v_lshlrev_b32 v5, 4, v5
    v_add_u32 v5, 151552, v5

    ds_read_b128 v[32:35], v5 offset:0
    ds_read_b128 v[36:39], v5 offset:32
    ds_read_b128 v[40:43], v5 offset:64
    ds_read_b128 v[44:47], v5 offset:96
    ds_read_b128 v[48:51], v5 offset:128
    ds_read_b128 v[52:55], v5 offset:160
    ds_read_b128 v[56:59], v5 offset:192
    ds_read_b128 v[60:63], v5 offset:224
    s_waitcnt lgkmcnt(0)
    s_lshl_b32 s57, s4, 1
    s_add_u32 s57, s57, s7
    s_lshl_b32 s57, s57, 15
    s_lshr_b32 s58, s5, 1
    s_lshl_b32 s58, s58, 9
    s_add_u32 s57, s57, s58
    s_add_u32 s64, s57, 1048576
    v_lshrrev_b32 v4, 5, v0
    v_lshlrev_b32 v4, 11, v4
    v_and_b32 v5, 31, v0
    v_lshl_add_u32 v4, v5, 4, v4
    s_mov_b32 s58, 0x0c04000c
    s_mov_b32 s59, 0x04020100
    s_lshl_b32 s65, s4, 1
    s_add_u32 s65, s65, s7
    s_lshl_b32 s65, s65, 11
    s_lshr_b32 s66, s5, 1
    s_lshl_b32 s66, s66, 8
    s_add_u32 s65, s65, s66
    s_add_u32 s65, s65, 278528
    v_lshrrev_b32 v8, 5, v0
    v_lshlrev_b32 v8, 10, v8
    v_and_b32 v5, 31, v0
    v_lshl_add_u32 v8, v5, 3, v8

    s_barrier
    s_mov_b32 s63, 0
L_pl_67:
    s_add_u32 s57, s64, 0
    buffer_load_dwordx4 v[64:67], v4, s[8:11], s57 offen sc1
    s_add_u32 s57, s64, 4096
    buffer_load_dwordx4 v[68:71], v4, s[8:11], s57 offen sc1
    s_add_u32 s57, s64, 8192
    buffer_load_dwordx4 v[72:75], v4, s[8:11], s57 offen sc1
    s_add_u32 s57, s64, 12288
    buffer_load_dwordx4 v[76:79], v4, s[8:11], s57 offen sc1
    s_add_u32 s57, s64, 16384
    buffer_load_dwordx4 v[80:83], v4, s[8:11], s57 offen sc1
    s_add_u32 s57, s64, 20480
    buffer_load_dwordx4 v[84:87], v4, s[8:11], s57 offen sc1
    s_add_u32 s57, s64, 24576
    buffer_load_dwordx4 v[88:91], v4, s[8:11], s57 offen sc1
    s_add_u32 s57, s64, 28672
    buffer_load_dwordx4 v[92:95], v4, s[8:11], s57 offen sc1
    s_add_u32 s63, s63, 1
    s_cmp_gt_u32 s63, 200000
    s_cbranch_scc1 L_plx_68
    s_waitcnt vmcnt(0)
    v_xor_b32 v96, v67, v3
    v_bitop3_b32 v96, v96, v71, v3 bitop3:0xf6
    v_bitop3_b32 v96, v96, v75, v3 bitop3:0xf6
    v_bitop3_b32 v96, v96, v79, v3 bitop3:0xf6
    v_bitop3_b32 v96, v96, v83, v3 bitop3:0xf6
    v_bitop3_b32 v96, v96, v87, v3 bitop3:0xf6
    v_bitop3_b32 v96, v96, v91, v3 bitop3:0xf6
    v_bitop3_b32 v96, v96, v95, v3 bitop3:0xf6
    v_cmp_ne_u32 vcc, 0, v96
    s_cbranch_vccnz L_pl_67
L_plx_68:
    s_waitcnt vmcnt(0)
    v_perm_b32 v67, v65, v64, s58
    v_perm_b32 v67, v66, v67, s59
    v_mul_f32 v100, v32, v64
    v_mul_f32 v101, v33, v65
    v_mul_f32 v102, v34, v66
    v_mul_f32 v103, v35, v67
    v_perm_b32 v71, v69, v68, s58
    v_perm_b32 v71, v70, v71, s59
    v_fmac_f32 v100, v36, v68
    v_fmac_f32 v101, v37, v69
    v_fmac_f32 v102, v38, v70
    v_fmac_f32 v103, v39, v71
    v_perm_b32 v75, v73, v72, s58
    v_perm_b32 v75, v74, v75, s59
    v_fmac_f32 v100, v40, v72
    v_fmac_f32 v101, v41, v73
    v_fmac_f32 v102, v42, v74
    v_fmac_f32 v103, v43, v75
    v_perm_b32 v79, v77, v76, s58
    v_perm_b32 v79, v78, v79, s59
    v_fmac_f32 v100, v44, v76
    v_fmac_f32 v101, v45, v77
    v_fmac_f32 v102, v46, v78
    v_fmac_f32 v103, v47, v79
    v_perm_b32 v83, v81, v80, s58
    v_perm_b32 v83, v82, v83, s59
    v_fmac_f32 v100, v48, v80
    v_fmac_f32 v101, v49, v81
    v_fmac_f32 v102, v50, v82
    v_fmac_f32 v103, v51, v83
    v_perm_b32 v87, v85, v84, s58
    v_perm_b32 v87, v86, v87, s59
    v_fmac_f32 v100, v52, v84
    v_fmac_f32 v101, v53, v85
    v_fmac_f32 v102, v54, v86
    v_fmac_f32 v103, v55, v87
    v_perm_b32 v91, v89, v88, s58
    v_perm_b32 v91, v90, v91, s59
    v_fmac_f32 v100, v56, v88
    v_fmac_f32 v101, v57, v89
    v_fmac_f32 v102, v58, v90
    v_fmac_f32 v103, v59, v91
    v_perm_b32 v95, v93, v92, s58
    v_perm_b32 v95, v94, v95, s59
    v_fmac_f32 v100, v60, v92
    v_fmac_f32 v101, v61, v93
    v_fmac_f32 v102, v62, v94
    v_fmac_f32 v103, v63, v95
    s_nop 1
    v_permlane32_swap_b32 v100, v102
    v_permlane32_swap_b32 v101, v103
    v_add_f32 v100, v100, v102
    v_add_f32 v101, v101, v103
    v_cvt_pk_bf16_f32 v100, v100, v101
    v_mov_b32 v101, v3

    s_cmp_eq_u32 s43, 2
    s_cbranch_scc0 L_ls_69
    buffer_store_dwordx2 v[100:101], v8, s[8:11], s65 offen
L_lb_70:
    v_mov_b32 v98, 131132
    v_mov_b32 v99, 1
    s_mov_b64 exec, 1
    ds_write_b32 v98, v99
    s_mov_b64 exec, -1
    s_and_b32 s65, s4, 3
    s_lshr_b32 s66, s4, 2
    s_and_b32 s57, s65, 1
    s_lshl_b32 s57, s57, 3
    s_lshl_b32 s58, s66, 2
    s_add_u32 s57, s57, s58
    v_and_b32 v10, 7, v0
    v_lshrrev_b32 v10, 1, v10
    v_add_u32 v10, s57, v10
    s_lshl_b32 s57, s5, 1
    s_lshr_b32 s58, s65, 1
    s_add_u32 s52, s57, s58
    v_lshrrev_b32 v4, 5, v0
    v_mul_u32_u24 v5, 24576, v4
    v_lshl_add_u32 v5, v10, 4, v5
    s_lshl_b32 s57, s52, 8
    s_add_u32 s64, s57, 28672
    s_add_u32 s67, s57, 77824

    s_mov_b32 s63, 0
L_pl_71:
    buffer_load_dwordx4 v[64:67], v5, s[8:11], s64 offen sc1
    buffer_load_dwordx4 v[68:71], v5, s[8:11], s67 offen sc1
    s_add_u32 s63, s63, 1
    s_cmp_gt_u32 s63, 200000
    s_cbranch_scc1 L_plx_72
    s_waitcnt vmcnt(0)
    v_xor_b32 v16, v66, v3
    v_bitop3_b32 v16, v16, v70, v3 bitop3:0xf6
    v_cmp_ne_u32 vcc, 0, v16
    s_cbranch_vccnz L_pl_71
L_plx_72:
    s_waitcnt vmcnt(0)
    v_pk_add_f32 v[64:65], v[64:65], v[68:69]
    v_cvt_pk_bf16_f32 v14, v64, v65
    v_and_b32 v11, 1, v0
    v_xor_b32 v11, 1, v11
    v_lshlrev_b32 v11, 4, v11
    v_lshlrev_b32 v29, v11, v14
    v_and_b32 v29, s68, v29
    v_lshlrev_b32 v12, 7, v4
    v_lshl_add_u32 v12, v10, 3, v12
    s_lshl_b32 s57, s52, 8
    s_lshl_b32 s58, s4, 12
    s_add_u32 s57, s57, s58
    s_add_u32 s53, s57, 458752

    s_and_b32 s65, s4, 3
    s_lshr_b32 s66, s4, 2
    v_lshrrev_b32 v4, 3, v0
    v_lshlrev_b32 v4, 13, v4
    v_and_b32 v5, 7, v0
    v_lshl_add_u32 v4, v5, 4, v4
    s_lshl_b32 s57, s5, 10
    s_lshl_b32 s58, s65, 8
    s_add_u32 s57, s57, s58
    s_lshl_b32 s58, s66, 7
    s_add_u32 s57, s57, s58
    s_add_u32 s64, s57, 589824

    s_mov_b32 s48, s38
    s_and_b32 s49, s39, 0xffff
    s_mov_b32 s50, 2048
    s_mov_b32 s51, 0x20000
    v_lshrrev_b32 v8, 5, v0
    v_lshlrev_b32 v8, 10, v8
    v_and_b32 v5, 7, v0
    v_lshl_add_u32 v8, v5, 1, v8
    s_lshl_b32 s57, s5, 7
    s_lshl_b32 s58, s65, 5
    s_add_u32 s57, s57, s58
    s_lshl_b32 s58, s66, 4
    s_add_u32 s67, s57, s58

    s_mov_b32 s63, 0
L_pl_73:
    buffer_load_dwordx2 v[26:27], v12, s[8:11], s53 offen sc1
    s_add_u32 s63, s63, 1
    s_cmp_gt_u32 s63, 200000
    s_cbranch_scc1 L_plx_74
    s_waitcnt vmcnt(0)
    v_cmp_ne_u32 vcc, v27, v3
    s_cbranch_vccnz L_pl_73
L_plx_74:
    s_waitcnt vmcnt(0)
    v_lshlrev_b32 v28, v11, v26
    v_and_b32 v28, s68, v28

    s_mov_b32 s63, 0
L_pl_75:
    s_add_u32 s57, s64, 0
    buffer_load_dwordx4 v[64:67], v4, s[8:11], s57 offen sc1
    s_add_u32 s57, s64, 65536
    buffer_load_dwordx4 v[68:71], v4, s[8:11], s57 offen sc1
    s_add_u32 s57, s64, 131072
    buffer_load_dwordx4 v[72:75], v4, s[8:11], s57 offen sc1
    s_add_u32 s57, s64, 196608
    buffer_load_dwordx4 v[76:79], v4, s[8:11], s57 offen sc1
    s_add_u32 s57, s64, 262144
    buffer_load_dwordx4 v[80:83], v4, s[8:11], s57 offen sc1
    s_add_u32 s57, s64, 327680
    buffer_load_dwordx4 v[84:87], v4, s[8:11], s57 offen sc1
    s_add_u32 s57, s64, 393216
    buffer_load_dwordx4 v[88:91], v4, s[8:11], s57 offen sc1
    s_add_u32 s63, s63, 1
    s_cmp_gt_u32 s63, 200000
    s_cbranch_scc1 L_plx_76
    s_waitcnt vmcnt(0)
    v_xor_b32 v96, v67, v3
    v_bitop3_b32 v96, v96, v71, v3 bitop3:0xf6
    v_bitop3_b32 v96, v96, v75, v3 bitop3:0xf6
    v_bitop3_b32 v96, v96, v79, v3 bitop3:0xf6
    v_bitop3_b32 v96, v96, v83, v3 bitop3:0xf6
    v_bitop3_b32 v96, v96, v87, v3 bitop3:0xf6
    v_bitop3_b32 v96, v96, v91, v3 bitop3:0xf6
    v_cmp_ne_u32 vcc, 0, v96
    s_cbranch_vccnz L_pl_75
L_plx_76:
    s_waitcnt vmcnt(0)
    v_pk_add_f32 v[98:99], v[64:65], v[68:69]
    v_pk_add_f32 v[100:101], v[72:73], v[76:77]
    v_pk_add_f32 v[102:103], v[80:81], v[84:85]
    v_pk_add_f32 v[98:99], v[98:99], v[88:89]
    v_pk_add_f32 v[100:101], v[100:101], v[102:103]
    v_pk_add_f32 v[98:99], v[98:99], v[100:101]
    s_nop 1
    v_permlane32_swap_b32 v98, v99
    v_add_f32 v98, v98, v99

    v_mov_b32 v96, v98
    s_nop 1
    v_permlane16_swap_b32 v98, v96
    v_add_f32 v98, v98, v96
    s_nop 1
    v_add_f32_dpp v98, v98, v98 row_ror:8 row_mask:0xf bank_mask:0xf
    v_cvt_pk_bf16_f32 v96, v98, v98
    v_lshlrev_b32 v96, 16, v96
    v_mul_f32 v96, v96, v29
    v_cvt_pk_bf16_f32 v96, v96, v96
    v_lshlrev_b32 v96, 16, v96
    v_add_f32 v96, v96, v28
    v_cvt_pk_bf16_f32 v96, v96, v96
    s_mov_b32 exec_lo, 0xff
    s_mov_b32 exec_hi, 0xff
    buffer_store_short v96, v8, s[48:51], s67 offen
    s_mov_b64 exec, -1
    s_cmp_eq_u32 s2, 0
    s_cbranch_scc0 L_noep
    v_mov_b32 v4, 0
    s_mov_b64 exec, 1
    buffer_store_dword v3, v4, s[8:11], 0 offen
    s_mov_b64 exec, -1
L_noep:

    s_endpgm
L_ls_5:
    buffer_store_dwordx4 v[68:71], v17, s[8:11], s66 offen sc1
    s_branch L_lb_6
L_ls_17:
    buffer_store_dwordx4 v[60:63], v4, s[8:11], s57 offen sc1
    s_branch L_lb_18
L_ls_23:
    buffer_store_dwordx4 v[46:49], v7, s[8:11], s64 offen sc1
    s_branch L_lb_24
L_ls_33:
    buffer_store_dwordx2 v[132:133], v19, s[8:11], s49 offen sc1
    s_branch L_lb_34
L_ls_35:
    buffer_store_dwordx4 v[136:139], v21, s[8:11], s50 offen sc1
    s_branch L_lb_36
L_ls_45:
    buffer_store_dwordx4 v[50:53], v8, s[8:11], s48 offen sc1
    s_branch L_lb_46
L_ls_69:
    buffer_store_dwordx2 v[100:101], v8, s[8:11], s65 offen sc1
    s_branch L_lb_70
L_code_end:
L_exit:
    s_endpgm
.section .rodata,"a"
.p2align 6
.amdhsa_kernel adaLN_cond__sliding_block_cached__geglu_ffn__decode_kernel
  .amdhsa_next_free_vgpr 144
  .amdhsa_next_free_sgpr 102
  .amdhsa_accum_offset 144
  .amdhsa_group_segment_fixed_size 0
  .amdhsa_kernarg_size 112
  .amdhsa_user_sgpr_count 2
  .amdhsa_user_sgpr_kernarg_segment_ptr 1
  .amdhsa_system_sgpr_workgroup_id_x 1
  .amdhsa_float_denorm_mode_32 3
.end_amdhsa_kernel
```
